```python
import torch

def _softmax(x, axis=-1):
    return torch.softmax(x, dim=axis)
def _gelu(x):
    return torch.nn.functional.gelu(x, approximate="tanh")
def _silu(x):
    return torch.nn.functional.silu(x)
def _sigmoid(x):
    return torch.sigmoid(x)
def _layernorm(x, axis=-1, eps=1e-5):
    m = x.mean(dim=axis, keepdim=True)
    v = x.var(dim=axis, keepdim=True, unbiased=False)
    return (x - m) / torch.sqrt(v + eps)
def _scatter_add(tgt, idx, src, axis=0):
    return tgt.clone().index_add_(axis, idx, src)
def _segment_sum(src, seg, n):
    out = torch.zeros((n,) + src.shape[1:], dtype=src.dtype)
    return out.index_add_(0, seg, src)
def _pad(x, pw):
    flat = tuple(v for pair in reversed(pw) for v in pair)
    return torch.nn.functional.pad(x, flat)

kernel_name = 'parallel_sum__ssm_conv_h3__glu_gated_swiglu__prompt'

def setup_inputs():

    _w = (lambda a: (lambda t: t.to(torch.bfloat16) if t.is_floating_point() else t)(torch.as_tensor(a)))
    def _A_setup():
        B, S, D = 1, 2048, 448
        ks = 4
        return {
            "q": _w((lambda *s: torch.randn(*s, dtype=torch.bfloat16) * 0.05)(B, S, D)),
            "k": _w((lambda *s: torch.randn(*s, dtype=torch.bfloat16) * 0.2)(B, S, D)),
            "v": _w((lambda *s: torch.randn(*s, dtype=torch.bfloat16) * 0.2)(B, S, D)),
            "shift_k": _w((lambda *s: torch.randn(*s, dtype=torch.bfloat16) * 0.2)(D, ks) * 0.5),
            "ssm_k": _w((lambda *s: torch.randn(*s, dtype=torch.bfloat16) * 0.4)(D, S) * (1.0 / S ** 0.5)),
            "ssm_D": _w((lambda *s: torch.randn(*s, dtype=torch.bfloat16) * 0.2)(D)),
        }
    _A_in = _A_setup()

    def _B_setup():
        B, S, D, F = 1, 2048, 448, 1792
        return {
            "x": _w((lambda *s: torch.randn(*s, dtype=torch.bfloat16) * 0.05)(B, S, D)),
            "w1": _w((lambda *s: torch.randn(*s, dtype=torch.bfloat16) * 0.2)(D, F) * (2.0 / D) ** 0.5),
            "w3": _w((lambda *s: torch.randn(*s, dtype=torch.bfloat16) * 0.2)(D, F) * (2.0 / D) ** 0.5),
            "w2": _w((lambda *s: torch.randn(*s, dtype=torch.bfloat16) * 0.2)(F, D) * (2.0 / F) ** 0.5),
        }
    _B_in = _B_setup()

    return {
        "A_q": _A_in["q"],
        "A_k": _A_in["k"],
        "A_v": _A_in["v"],
        "A_shift_k": _A_in["shift_k"],
        "A_ssm_k": _A_in["ssm_k"],
        "A_ssm_D": _A_in["ssm_D"],
        "B_x": _B_in["x"],
        "B_w1": _B_in["w1"],
        "B_w3": _B_in["w3"],
        "B_w2": _B_in["w2"],
    }

def reference(A_q, A_k, A_v, A_shift_k, A_ssm_k, A_ssm_D, B_x, B_w1, B_w3, B_w2):
    def _A_ref(q, k, v, shift_k, ssm_k, ssm_D):
        B, S, D = q.shape
        ks = shift_k.shape[-1]
        k_pad = _pad(k, ((0, 0), (ks - 1, 0), (0, 0)))
        k_shift = torch.zeros_like(k)
        for t in range(ks):
            k_shift = k_shift + k_pad[:, t:t + S, :] * shift_k[:, ks - 1 - t][None, None, :]
        kv = k_shift * v
        L = 2 * S
        kv_pad = _pad(kv, ((0, 0), (0, S), (0, 0)))
        kf_pad = _pad(ssm_k, ((0, 0), (0, S)))
        kv_f = (lambda x, axes=(-2,-1): torch.fft.rfft2(x.float(), dim=axes))(kv_pad[:, None, :, :], axes=(1, 2))
        kf_f = (lambda x, axes=(-2,-1): torch.fft.rfft2(x.float(), dim=axes))(kf_pad[:, None, :], axes=(1, 2))
        kf_f = (lambda x, *d: x.permute(*d))(kf_f, 1, 2, 0)
        y_f = kv_f * kf_f[None, :, :, :]
        y = (lambda x, s, axes=(-2,-1): torch.fft.irfft2(x, s=s, dim=axes).to(torch.bfloat16))(y_f, (1, L), axes=(1, 2))[:, 0, :S, :]
        y = y + kv * ssm_D[None, None, :]
        return q * y

    def _B_ref(x, w1, w3, w2):
        gate = torch.einsum("bsd,df->bsf", x, w1)
        up = torch.einsum("bsd,df->bsf", x, w3)
        h = _silu(gate) * up
        out = torch.einsum("bsf,fd->bsd", h, w2)
        return out

    x = A_q
    xn = _layernorm(x, axis=-1)
    return x + _A_ref(xn, A_k, A_v, A_shift_k, A_ssm_k, A_ssm_D) + _B_ref(xn, B_w1, B_w3, B_w2)
```

```asm
; @launch grid=(256,1,1) block=(512,1,1) lds=163840
.amdgcn_target "amdgcn-amd-amdhsa--gfx950"
.text
.globl parallel_sum__ssm_conv_h3__glu_gated_swiglu__prompt_kernel
.p2align 8
.type parallel_sum__ssm_conv_h3__glu_gated_swiglu__prompt_kernel,@function
parallel_sum__ssm_conv_h3__glu_gated_swiglu__prompt_kernel:
    s_cmp_ge_u32 s2, 256
    s_cbranch_scc1 L_exit
    s_add_u32 s2, s2, 224
    s_and_b32 s2, s2, 255
    s_load_dwordx16 s[72:87], s[0:1], 0
    s_load_dwordx8 s[88:95], s[0:1], 64
    s_load_dwordx2 s[32:33], s[0:1], 96
    v_and_b32 v1, 63, v0
    v_lshrrev_b32 v2, 6, v0
    s_nop 0
    v_readfirstlane_b32 s3, v2
    s_mov_b32 s6, 1835008
    s_mov_b32 s7, 0x00020000
    s_mov_b32 s10, 1835008
    s_mov_b32 s11, 0x00020000
    s_mov_b32 s14, 1835008
    s_mov_b32 s15, 0x00020000
    s_mov_b32 s42, 3584
    s_mov_b32 s43, 0x00020000
    s_mov_b32 s18, 1835008
    s_mov_b32 s19, 0x00020000
    s_mov_b32 s22, 1605632
    s_mov_b32 s23, 0x00020000
    s_mov_b32 s26, 1605632
    s_mov_b32 s27, 0x00020000
    s_mov_b32 s30, 1835008
    s_mov_b32 s31, 0x00020000
    s_mov_b32 s34, 18874368
    s_mov_b32 s35, 0x00020000
    s_and_b32 s48, s2, 7
    s_lshr_b32 s49, s2, 3
    s_mul_i32 s50, s49, 37
    s_lshr_b32 s50, s50, 8
    s_mul_i32 s51, s50, 7
    s_sub_u32 s51, s49, s51
    s_cmp_ge_u32 s2, 224
    s_cbranch_scc1 L_free
    s_and_b32 s64, s48, 3
    s_lshl_b32 s64, s64, 2
    s_add_u32 s52, s64, s50
    s_lshr_b32 s64, s48, 2
    s_mul_i32 s64, s64, 7
    s_add_u32 s53, s64, s51
    s_and_b32 s66, s3, 4
    s_lshl_b32 s64, s52, 7
    s_lshl_b32 s65, s3, 4
    s_add_u32 s64, s64, s65
    s_mul_i32 s55, s64, 896
    s_and_b32 s64, s3, 3
    s_mul_i32 s56, s64, 57344
    s_lshl_b32 s65, s53, 8
    s_add_u32 s56, s56, s65
    s_lshl_b32 s57, s3, 11
    s_lshl_b32 s58, s64, 12
    s_mul_i32 s65, s66, 12288
    s_add_u32 s58, s58, s65
    s_add_u32 s58, s58, 49152
    v_lshrrev_b32 v8, 3, v1
    v_and_b32 v9, 7, v1
    v_lshrrev_b32 v10, 1, v8
    v_xor_b32 v10, v9, v10
    v_mul_u32_u24 v11, 896, v8
    v_lshl_add_u32 v2, v10, 4, v11
    v_xor_b32 v10, 4, v10
    v_lshl_add_u32 v3, v10, 4, v11
    v_add_u32 v3, 6144, v3
    v_lshrrev_b32 v8, 4, v1
    v_bfe_u32 v9, v1, 1, 3
    v_xor_b32 v9, v9, v8
    v_xor_b32 v9, s66, v9
    v_and_b32 v10, 1, v1
    v_lshlrev_b32 v10, 4, v10
    v_lshl_add_u32 v10, v9, 5, v10
    v_mul_u32_u24 v11, 3584, v8
    v_add_u32 v4, v10, v11
    v_add_u32 v5, 13312, v4
    v_add_u32 v6, 26624, v4
    v_add_u32 v7, 39936, v4
    s_waitcnt lgkmcnt(0)
    s_mov_b64 s[4:5], s[72:73]
    s_mov_b64 s[20:21], s[86:87]
    s_mov_b64 s[46:47], s[88:89]
    s_mov_b64 s[8:9], s[74:75]
    s_mov_b64 s[12:13], s[76:77]
    s_mov_b64 s[40:41], s[78:79]
    s_mov_b64 s[16:17], s[80:81]
    s_mov_b64 s[44:45], s[82:83]
    s_mov_b64 s[24:25], s[90:91]
    s_mov_b64 s[28:29], s[92:93]
    s_cmp_ge_u32 s3, 4
    s_cselect_b32 s20, s46, s20
    s_cselect_b32 s21, s47, s21
    s_and_b32 s47, s48, 3
    s_lshl_b32 s47, s47, 1
    s_and_b32 s64, s50, 1
    s_add_u32 s47, s47, s64
    s_cmp_eq_u32 s47, 7
    s_cselect_b32 s47, 0, s47
    s_mov_b32 s70, 13631488
    s_load_dword s71, s[32:33], s70
    s_mul_i32 s69, s47, 229376
    s_add_u32 s69, s69, s56
    s_add_u32 m0, s58, 0
    s_nop 0
    buffer_load_dwordx4 v4, s[20:23], s69 offen offset:0 lds
    s_mul_i32 s69, s47, 229376
    s_add_u32 s69, s69, s56
    s_add_u32 m0, s58, 0
    s_nop 0
    buffer_load_dwordx4 v5, s[20:23], s69 offen offset:1024 lds
    s_mul_i32 s69, s47, 229376
    s_add_u32 s69, s69, s56
    s_add_u32 m0, s58, 0
    s_nop 0
    buffer_load_dwordx4 v6, s[20:23], s69 offen offset:2048 lds
    s_mul_i32 s69, s47, 229376
    s_add_u32 s69, s69, s56
    s_add_u32 m0, s58, 0
    s_nop 0
    buffer_load_dwordx4 v7, s[20:23], s69 offen offset:3072 lds
    s_lshl_b32 s69, s47, 7
    s_add_u32 s69, s69, s55
    s_add_u32 m0, s57, 0
    s_nop 0
    buffer_load_dwordx4 v2, s[4:7], s69 offen offset:0 lds
    s_lshl_b32 s69, s47, 7
    s_add_u32 s69, s69, s55
    s_add_u32 m0, s57, 0
    s_nop 0
    buffer_load_dwordx4 v3, s[4:7], s69 offen offset:1024 lds
    s_add_u32 s47, s47, 1
    s_cmp_ge_u32 s47, 7
    s_cselect_b32 s47, 0, s47
    s_and_b32 s61, s3, 1
    s_lshr_b32 s60, s3, 1
    v_and_b32 v14, 31, v1
    v_lshrrev_b32 v15, 5, v1
    v_bfe_u32 v16, v1, 1, 3
    v_xor_b32 v16, v16, v15
    s_lshl_b32 s64, s61, 13
    v_lshl_add_u32 v17, v14, 7, s64
    v_xor_b32 v18, 0, v16
    v_lshl_add_u32 v8, v18, 4, v17
    v_xor_b32 v18, 2, v16
    v_lshl_add_u32 v9, v18, 4, v17
    v_xor_b32 v18, 4, v16
    v_lshl_add_u32 v10, v18, 4, v17
    v_xor_b32 v18, 6, v16
    v_lshl_add_u32 v11, v18, 4, v17
    v_bfe_u32 v16, v1, 4, 1
    v_bfe_u32 v17, v1, 2, 2
    v_lshl_add_u32 v18, v15, 3, v17
    v_lshlrev_b32 v18, 8, v18
    v_mul_u32_u24 v19, 49152, v16
    v_add_u32 v18, v18, v19
    v_add_u32 v18, 49152, v18
    v_and_b32 v19, 1, v1
    v_lshlrev_b32 v19, 4, v19
    v_bfe_u32 v20, v1, 1, 1
    v_lshl_add_u32 v19, v20, 3, v19
    v_add_u32 v18, v18, v19
    v_lshlrev_b32 v16, 2, v16
    v_xor_b32 v16, v16, v17
    s_lshl_b32 s64, s60, 1
    v_xor_b32 v16, s64, v16
    v_lshl_add_u32 v12, v16, 5, v18
    v_xor_b32 v16, 1, v16
    v_lshl_add_u32 v13, v16, 5, v18
    v_lshlrev_b32 v56, 4, v1
    s_and_b32 s64, s48, 3
    s_lshl_b32 s64, s64, 3
    s_and_b32 s65, s48, 4
    s_add_u32 s54, s64, s65
    s_add_u32 s54, s54, s50
    s_mul_i32 s65, s60, 28
    s_lshl_b32 s64, s54, 1
    s_add_u32 s64, s64, s61
    s_mul_i32 s64, s64, 112
    s_add_u32 s64, s64, s65
    s_lshl_b32 s64, s64, 10
    s_add_u32 s59, s64, 2097152
    s_lshl_b32 s64, s51, 1
    s_add_u32 s64, s64, s61
    s_mul_i32 s64, s64, 112
    s_add_u32 s64, s64, s65
    s_lshl_b32 s64, s64, 10
    s_add_u32 s63, s64, 16777216
    s_lshl_b32 s64, s61, 1
    s_or_b32 s46, s64, s50
    s_and_b32 s64, s48, 3
    s_lshl_b32 s64, s64, 1
    s_add_u32 s64, s64, s50
    s_cmp_eq_u32 s64, 7
    s_cselect_b32 s64, 0, 0x3f803f80
    v_mov_b32 v204, s64
    v_mov_b32 v205, s64
    v_mov_b32 v206, s64
    v_mov_b32 v207, s64
    s_waitcnt lgkmcnt(0)
    s_add_u32 s71, s71, 0x9e3779b9
    s_barrier
    s_mul_i32 s69, s47, 229376
    s_add_u32 s69, s69, s56
    s_add_u32 m0, s58, 16384
    s_nop 0
    buffer_load_dwordx4 v4, s[20:23], s69 offen offset:0 lds
    s_mul_i32 s69, s47, 229376
    s_add_u32 s69, s69, s56
    s_add_u32 m0, s58, 16384
    s_nop 0
    buffer_load_dwordx4 v5, s[20:23], s69 offen offset:1024 lds
    s_mul_i32 s69, s47, 229376
    s_add_u32 s69, s69, s56
    s_add_u32 m0, s58, 16384
    s_nop 0
    buffer_load_dwordx4 v6, s[20:23], s69 offen offset:2048 lds
    s_mul_i32 s69, s47, 229376
    s_add_u32 s69, s69, s56
    s_add_u32 m0, s58, 16384
    s_nop 0
    buffer_load_dwordx4 v7, s[20:23], s69 offen offset:3072 lds
    s_lshl_b32 s69, s47, 7
    s_add_u32 s69, s69, s55
    s_add_u32 m0, s57, 16384
    s_nop 0
    buffer_load_dwordx4 v2, s[4:7], s69 offen offset:0 lds
    s_lshl_b32 s69, s47, 7
    s_add_u32 s69, s69, s55
    s_add_u32 m0, s57, 16384
    s_nop 0
    buffer_load_dwordx4 v3, s[4:7], s69 offen offset:1024 lds
    s_add_u32 s47, s47, 1
    s_cmp_ge_u32 s47, 7
    s_cselect_b32 s47, 0, s47
    s_waitcnt vmcnt(6)
    s_barrier
    ds_read_b64_tr_b16 v[24:25], v12 offset:0
    ds_read_b64_tr_b16 v[26:27], v12 offset:1024
    ds_read_b128 v[16:19], v8 offset:0
    ds_read_b128 v[20:23], v8 offset:4096
    ds_read_b64_tr_b16 v[28:29], v13 offset:0
    ds_read_b64_tr_b16 v[30:31], v13 offset:1024
    s_waitcnt lgkmcnt(3)
    v_mfma_f32_32x32x16_bf16 v[64:79], v[24:27], v[16:19], 0
    ds_read_b64_tr_b16 v[40:41], v12 offset:4096
    ds_read_b64_tr_b16 v[42:43], v12 offset:5120
    s_mul_i32 s69, s47, 229376
    s_add_u32 s69, s69, s56
    s_add_u32 m0, s58, 32768
    s_nop 0
    buffer_load_dwordx4 v4, s[20:23], s69 offen offset:0 lds
    s_waitcnt lgkmcnt(4)
    v_mfma_f32_32x32x16_bf16 v[80:95], v[24:27], v[20:23], 0
    ds_read_b128 v[32:35], v9 offset:0
    ds_read_b128 v[36:39], v9 offset:4096
    s_mul_i32 s69, s47, 229376
    s_add_u32 s69, s69, s56
    s_add_u32 m0, s58, 32768
    s_nop 0
    buffer_load_dwordx4 v5, s[20:23], s69 offen offset:1024 lds
    s_waitcnt lgkmcnt(4)
    v_mfma_f32_32x32x16_bf16 v[96:111], v[28:31], v[16:19], 0
    ds_read_b64_tr_b16 v[44:45], v13 offset:4096
    ds_read_b64_tr_b16 v[46:47], v13 offset:5120
    v_mfma_f32_32x32x16_bf16 v[112:127], v[28:31], v[20:23], 0
    s_cmp_ge_u32 s46, 2
    s_cbranch_scc1 L_cs_1
    v_mfma_f32_32x32x16_bf16 v[208:223], v[204:207], v[24:27], 0
    v_mfma_f32_32x32x16_bf16 v[224:239], v[204:207], v[28:31], 0
L_cs_1:
    s_waitcnt lgkmcnt(3)
    v_mfma_f32_32x32x16_bf16 v[64:79], v[40:43], v[32:35], v[64:79]
    ds_read_b64_tr_b16 v[24:25], v12 offset:8192
    ds_read_b64_tr_b16 v[26:27], v12 offset:9216
    s_mul_i32 s69, s47, 229376
    s_add_u32 s69, s69, s56
    s_add_u32 m0, s58, 32768
    s_nop 0
    buffer_load_dwordx4 v6, s[20:23], s69 offen offset:2048 lds
    s_waitcnt lgkmcnt(4)
    v_mfma_f32_32x32x16_bf16 v[80:95], v[40:43], v[36:39], v[80:95]
    ds_read_b128 v[16:19], v10 offset:0
    ds_read_b128 v[20:23], v10 offset:4096
    s_mul_i32 s69, s47, 229376
    s_add_u32 s69, s69, s56
    s_add_u32 m0, s58, 32768
    s_nop 0
    buffer_load_dwordx4 v7, s[20:23], s69 offen offset:3072 lds
    s_waitcnt lgkmcnt(4)
    v_mfma_f32_32x32x16_bf16 v[96:111], v[44:47], v[32:35], v[96:111]
    ds_read_b64_tr_b16 v[28:29], v13 offset:8192
    ds_read_b64_tr_b16 v[30:31], v13 offset:9216
    v_mfma_f32_32x32x16_bf16 v[112:127], v[44:47], v[36:39], v[112:127]
    s_cmp_ge_u32 s46, 2
    s_cbranch_scc1 L_cs_2
    v_mfma_f32_32x32x16_bf16 v[208:223], v[204:207], v[40:43], v[208:223]
    v_mfma_f32_32x32x16_bf16 v[224:239], v[204:207], v[44:47], v[224:239]
L_cs_2:
    s_waitcnt lgkmcnt(3)
    v_mfma_f32_32x32x16_bf16 v[64:79], v[24:27], v[16:19], v[64:79]
    ds_read_b64_tr_b16 v[40:41], v12 offset:12288
    ds_read_b64_tr_b16 v[42:43], v12 offset:13312
    s_lshl_b32 s69, s47, 7
    s_add_u32 s69, s69, s55
    s_add_u32 m0, s57, 32768
    s_nop 0
    buffer_load_dwordx4 v2, s[4:7], s69 offen offset:0 lds
    s_waitcnt lgkmcnt(4)
    v_mfma_f32_32x32x16_bf16 v[80:95], v[24:27], v[20:23], v[80:95]
    ds_read_b128 v[32:35], v11 offset:0
    ds_read_b128 v[36:39], v11 offset:4096
    s_lshl_b32 s69, s47, 7
    s_add_u32 s69, s69, s55
    s_add_u32 m0, s57, 32768
    s_nop 0
    buffer_load_dwordx4 v3, s[4:7], s69 offen offset:1024 lds
    s_add_u32 s47, s47, 1
    s_cmp_ge_u32 s47, 7
    s_cselect_b32 s47, 0, s47
    s_waitcnt lgkmcnt(4)
    v_mfma_f32_32x32x16_bf16 v[96:111], v[28:31], v[16:19], v[96:111]
    ds_read_b64_tr_b16 v[44:45], v13 offset:12288
    ds_read_b64_tr_b16 v[46:47], v13 offset:13312
    s_mul_i32 s64, s2, 9363
    s_lshr_b32 s64, s64, 16
    s_mul_i32 s65, s64, 7
    s_sub_u32 s65, s2, s65
    s_lshl_b32 s66, s64, 3
    v_mfma_f32_32x32x16_bf16 v[112:127], v[28:31], v[20:23], v[112:127]
    s_add_u32 s66, s66, s3
    s_mul_i32 s66, s66, 7168
    s_lshl_b32 s67, s65, 7
    s_add_u32 s66, s66, s67
    v_lshrrev_b32 v50, 3, v1
    s_cmp_ge_u32 s46, 2
    s_cbranch_scc1 L_cs_3
    v_mfma_f32_32x32x16_bf16 v[208:223], v[204:207], v[24:27], v[208:223]
    v_mfma_f32_32x32x16_bf16 v[224:239], v[204:207], v[28:31], v[224:239]
L_cs_3:
    s_waitcnt lgkmcnt(0)
    s_waitcnt vmcnt(6)
    s_barrier
    v_mfma_f32_32x32x16_bf16 v[64:79], v[40:43], v[32:35], v[64:79]
    ds_read_b64_tr_b16 v[24:25], v12 offset:16384
    ds_read_b64_tr_b16 v[26:27], v12 offset:17408
    v_and_b32 v49, 7, v1
    v_mul_u32_u24 v48, 896, v50
    v_lshl_add_u32 v48, v49, 4, v48
    s_lshl_b32 s67, s3, 10
    v_mfma_f32_32x32x16_bf16 v[80:95], v[40:43], v[36:39], v[80:95]
    ds_read_b128 v[16:19], v8 offset:16384
    ds_read_b128 v[20:23], v8 offset:20480
    s_add_u32 m0, s67, 147456
    s_nop 0
    buffer_load_dwordx4 v48, s[8:11], s66 offen lds
    s_add_u32 m0, s67, 155648
    s_nop 0
    buffer_load_dwordx4 v48, s[12:15], s66 offen lds
    v_mfma_f32_32x32x16_bf16 v[96:111], v[44:47], v[32:35], v[96:111]
    ds_read_b64_tr_b16 v[28:29], v13 offset:16384
    ds_read_b64_tr_b16 v[30:31], v13 offset:17408
    s_sub_u32 s66, s66, 2688
    v_lshl_add_u32 v48, v1, 1, s66
    v_mov_b32 v132, 0
    v_mov_b32 v133, 0
    v_mfma_f32_32x32x16_bf16 v[112:127], v[44:47], v[36:39], v[112:127]
    v_mov_b32 v134, 0
    s_lshl_b32 s66, s65, 9
    v_lshl_add_u32 v51, v1, 3, s66
    s_cmp_ge_u32 s46, 2
    s_cbranch_scc1 L_cs_4
    v_mfma_f32_32x32x16_bf16 v[208:223], v[204:207], v[40:43], v[208:223]
    v_mfma_f32_32x32x16_bf16 v[224:239], v[204:207], v[44:47], v[224:239]
L_cs_4:
    s_waitcnt lgkmcnt(3)
    v_mfma_f32_32x32x16_bf16 v[64:79], v[24:27], v[16:19], v[64:79]
    ds_read_b64_tr_b16 v[40:41], v12 offset:20480
    ds_read_b64_tr_b16 v[42:43], v12 offset:21504
    buffer_load_short_d16_hi v132, v48, s[8:11], 0 offen offset:0
    buffer_load_short_d16_hi v133, v48, s[8:11], 0 offen offset:896
    buffer_load_short_d16_hi v134, v48, s[8:11], 0 offen offset:1792
    buffer_load_dwordx2 v[160:161], v51, s[40:43], 0 offen
    s_waitcnt lgkmcnt(4)
    v_mfma_f32_32x32x16_bf16 v[80:95], v[24:27], v[20:23], v[80:95]
    ds_read_b128 v[32:35], v9 offset:16384
    ds_read_b128 v[36:39], v9 offset:20480
    s_lshl_b32 s65, s65, 3
    s_add_u32 s65, s65, s3
    s_lshl_b32 s65, s65, 15
    s_lshl_b32 s64, s64, 7
    s_sub_u32 s65, s65, s64
    s_waitcnt lgkmcnt(4)
    v_mfma_f32_32x32x16_bf16 v[96:111], v[28:31], v[16:19], v[96:111]
    ds_read_b64_tr_b16 v[44:45], v13 offset:20480
    ds_read_b64_tr_b16 v[46:47], v13 offset:21504
    s_add_u32 s65, s65, 3968
    v_lshl_add_u32 v181, v50, 12, s65
    v_lshl_add_u32 v181, v49, 4, v181
    s_lshl_b32 s64, s3, 7
    s_add_u32 s64, s64, 154624
    v_mfma_f32_32x32x16_bf16 v[112:127], v[28:31], v[20:23], v[112:127]
    v_lshl_add_u32 v182, v50, 4, s64
    v_lshlrev_b32 v48, 10, v49
    v_sub_u32 v182, v182, v48
    v_bfe_u32 v48, v1, 2, 2
    v_lshlrev_b32 v48, 7, v48
    s_waitcnt lgkmcnt(3)
    v_mfma_f32_32x32x16_bf16 v[64:79], v[40:43], v[32:35], v[64:79]
    ds_read_b64_tr_b16 v[24:25], v12 offset:24576
    ds_read_b64_tr_b16 v[26:27], v12 offset:25600
    v_lshrrev_b32 v49, 4, v1
    v_lshl_add_u32 v48, v49, 5, v48
    v_and_b32 v49, 3, v1
    v_lshl_add_u32 v48, v49, 3, v48
    s_add_u32 s67, s67, 147456
    s_waitcnt lgkmcnt(4)
    v_mfma_f32_32x32x16_bf16 v[80:95], v[40:43], v[36:39], v[80:95]
    ds_read_b128 v[16:19], v10 offset:16384
    ds_read_b128 v[20:23], v10 offset:20480
    v_add_u32 v180, s67, v48
    v_add_u32 v183, s67, v56
    s_waitcnt lgkmcnt(4)
    v_mfma_f32_32x32x16_bf16 v[96:111], v[44:47], v[32:35], v[96:111]
    ds_read_b64_tr_b16 v[28:29], v13 offset:24576
    ds_read_b64_tr_b16 v[30:31], v13 offset:25600
    s_mul_i32 s69, s47, 229376
    s_add_u32 s69, s69, s56
    s_add_u32 m0, s58, 0
    s_nop 0
    buffer_load_dwordx4 v4, s[20:23], s69 offen offset:0 lds
    s_cmp_ge_u32 s46, 2
    s_cbranch_scc1 L_ncs_5
    s_lshl_b32 s64, s53, 3
    s_lshl_b32 s65, s60, 1
    s_add_u32 s64, s64, s65
    s_lshl_b32 s64, s64, 3
    s_and_b32 s65, s48, 3
    s_lshl_b32 s65, s65, 1
    s_add_u32 s64, s64, s65
    s_add_u32 s64, s64, s50
    s_lshl_b32 s64, s64, 7
    s_add_u32 s64, s64, 12648448
    v_lshlrev_b32 v48, 2, v1
    s_mov_b32 exec_hi, 0
    v_cvt_pk_bf16_f32 v49, v208, v208
    v_and_b32 v49, 0xffff0000, v49
    v_sub_f32 v50, v208, v49
    v_cvt_pk_bf16_f32 v50, v49, v50
    buffer_store_dword v50, v48, s[32:35], s64 offen offset:0 sc1
    v_cvt_pk_bf16_f32 v49, v224, v224
    v_and_b32 v49, 0xffff0000, v49
    v_sub_f32 v50, v224, v49
    v_cvt_pk_bf16_f32 v51, v49, v50
    buffer_store_dword v51, v48, s[32:35], s64 offen offset:1024 sc1
    s_mov_b64 exec, -1
L_ncs_5:
    v_mfma_f32_32x32x16_bf16 v[112:127], v[44:47], v[36:39], v[112:127]
    s_mul_i32 s69, s47, 229376
    s_add_u32 s69, s69, s56
    s_add_u32 m0, s58, 0
    s_nop 0
    buffer_load_dwordx4 v5, s[20:23], s69 offen offset:1024 lds
    s_waitcnt lgkmcnt(3)
    v_mfma_f32_32x32x16_bf16 v[64:79], v[24:27], v[16:19], v[64:79]
    ds_read_b64_tr_b16 v[40:41], v12 offset:28672
    ds_read_b64_tr_b16 v[42:43], v12 offset:29696
    s_waitcnt lgkmcnt(4)
    v_mfma_f32_32x32x16_bf16 v[80:95], v[24:27], v[20:23], v[80:95]
    ds_read_b128 v[32:35], v11 offset:16384
    ds_read_b128 v[36:39], v11 offset:20480
    s_waitcnt lgkmcnt(4)
    v_mfma_f32_32x32x16_bf16 v[96:111], v[28:31], v[16:19], v[96:111]
    ds_read_b64_tr_b16 v[44:45], v13 offset:28672
    ds_read_b64_tr_b16 v[46:47], v13 offset:29696
    s_mul_i32 s69, s47, 229376
    s_add_u32 s69, s69, s56
    s_add_u32 m0, s58, 0
    s_nop 0
    buffer_load_dwordx4 v6, s[20:23], s69 offen offset:2048 lds
    v_mfma_f32_32x32x16_bf16 v[112:127], v[28:31], v[20:23], v[112:127]
    s_mul_i32 s69, s47, 229376
    s_add_u32 s69, s69, s56
    s_add_u32 m0, s58, 0
    s_nop 0
    buffer_load_dwordx4 v7, s[20:23], s69 offen offset:3072 lds
    s_waitcnt lgkmcnt(0)
    s_waitcnt vmcnt(10)
    s_barrier
    v_mfma_f32_32x32x16_bf16 v[64:79], v[40:43], v[32:35], v[64:79]
    ds_read_b64_tr_b16 v[24:25], v12 offset:32768
    ds_read_b64_tr_b16 v[26:27], v12 offset:33792
    v_mfma_f32_32x32x16_bf16 v[80:95], v[40:43], v[36:39], v[80:95]
    ds_read_b128 v[16:19], v8 offset:32768
    ds_read_b128 v[20:23], v8 offset:36864
    v_mfma_f32_32x32x16_bf16 v[96:111], v[44:47], v[32:35], v[96:111]
    ds_read_b64_tr_b16 v[28:29], v13 offset:32768
    ds_read_b64_tr_b16 v[30:31], v13 offset:33792
    s_lshl_b32 s69, s47, 7
    s_add_u32 s69, s69, s55
    s_add_u32 m0, s57, 0
    s_nop 0
    buffer_load_dwordx4 v2, s[4:7], s69 offen offset:0 lds
    s_waitcnt vmcnt(5)
    ds_read_b64_tr_b16 v[144:145], v180 offset:0
    ds_read_b64_tr_b16 v[146:147], v180 offset:512
    ds_read_b64_tr_b16 v[148:149], v180 offset:8192
    ds_read_b64_tr_b16 v[150:151], v180 offset:8704
    v_mfma_f32_32x32x16_bf16 v[112:127], v[44:47], v[36:39], v[112:127]
    s_lshl_b32 s69, s47, 7
    s_add_u32 s69, s69, s55
    s_add_u32 m0, s57, 0
    s_nop 0
    buffer_load_dwordx4 v3, s[4:7], s69 offen offset:1024 lds
    s_add_u32 s47, s47, 1
    s_cmp_ge_u32 s47, 7
    s_cselect_b32 s47, 0, s47
    v_lshlrev_b32 v162, 16, v160
    v_and_b32 v163, 0xffff0000, v160
    v_lshlrev_b32 v164, 16, v161
    v_and_b32 v165, 0xffff0000, v161
    s_waitcnt lgkmcnt(7)
    v_mfma_f32_32x32x16_bf16 v[64:79], v[24:27], v[16:19], v[64:79]
    ds_read_b64_tr_b16 v[40:41], v12 offset:36864
    ds_read_b64_tr_b16 v[42:43], v12 offset:37888
    s_waitcnt lgkmcnt(8)
    v_mfma_f32_32x32x16_bf16 v[80:95], v[24:27], v[20:23], v[80:95]
    ds_read_b128 v[32:35], v9 offset:32768
    ds_read_b128 v[36:39], v9 offset:36864
    s_waitcnt lgkmcnt(4)
    v_lshlrev_b32 v135, 16, v144
    v_and_b32 v136, 0xffff0000, v144
    v_lshlrev_b32 v137, 16, v145
    v_and_b32 v138, 0xffff0000, v145
    v_lshlrev_b32 v139, 16, v146
    s_waitcnt lgkmcnt(8)
    v_mfma_f32_32x32x16_bf16 v[96:111], v[28:31], v[16:19], v[96:111]
    ds_read_b64_tr_b16 v[44:45], v13 offset:36864
    ds_read_b64_tr_b16 v[46:47], v13 offset:37888
    s_mul_i32 s69, s47, 229376
    s_add_u32 s69, s69, s56
    s_add_u32 m0, s58, 16384
    s_nop 0
    buffer_load_dwordx4 v4, s[20:23], s69 offen offset:0 lds
    v_and_b32 v140, 0xffff0000, v146
    v_lshlrev_b32 v141, 16, v147
    v_and_b32 v142, 0xffff0000, v147
    v_mul_f32 v166, v165, v132
    v_mul_f32 v167, v165, v133
    v_mfma_f32_32x32x16_bf16 v[112:127], v[28:31], v[20:23], v[112:127]
    s_mul_i32 s69, s47, 229376
    s_add_u32 s69, s69, s56
    s_add_u32 m0, s58, 16384
    s_nop 0
    buffer_load_dwordx4 v5, s[20:23], s69 offen offset:1024 lds
    v_mul_f32 v168, v165, v134
    v_mul_f32 v169, v165, v135
    v_mul_f32 v170, v165, v136
    v_mul_f32 v171, v165, v137
    v_mul_f32 v172, v165, v138
    s_waitcnt lgkmcnt(3)
    v_mfma_f32_32x32x16_bf16 v[64:79], v[40:43], v[32:35], v[64:79]
    ds_read_b64_tr_b16 v[24:25], v12 offset:40960
    ds_read_b64_tr_b16 v[26:27], v12 offset:41984
    v_mul_f32 v173, v165, v139
    v_fmac_f32 v166, v164, v133
    v_fmac_f32 v167, v164, v134
    v_fmac_f32 v168, v164, v135
    v_fmac_f32 v169, v164, v136
    s_waitcnt lgkmcnt(4)
    v_mfma_f32_32x32x16_bf16 v[80:95], v[40:43], v[36:39], v[80:95]
    ds_read_b128 v[16:19], v10 offset:32768
    ds_read_b128 v[20:23], v10 offset:36864
    v_fmac_f32 v170, v164, v137
    v_fmac_f32 v171, v164, v138
    v_fmac_f32 v172, v164, v139
    v_fmac_f32 v173, v164, v140
    v_fmac_f32 v166, v163, v134
    s_waitcnt lgkmcnt(4)
    v_mfma_f32_32x32x16_bf16 v[96:111], v[44:47], v[32:35], v[96:111]
    ds_read_b64_tr_b16 v[28:29], v13 offset:40960
    ds_read_b64_tr_b16 v[30:31], v13 offset:41984
    s_mul_i32 s69, s47, 229376
    s_add_u32 s69, s69, s56
    s_add_u32 m0, s58, 16384
    s_nop 0
    buffer_load_dwordx4 v6, s[20:23], s69 offen offset:2048 lds
    v_fmac_f32 v167, v163, v135
    v_fmac_f32 v168, v163, v136
    v_fmac_f32 v169, v163, v137
    v_fmac_f32 v170, v163, v138
    v_fmac_f32 v171, v163, v139
    v_mfma_f32_32x32x16_bf16 v[112:127], v[44:47], v[36:39], v[112:127]
    s_mul_i32 s69, s47, 229376
    s_add_u32 s69, s69, s56
    s_add_u32 m0, s58, 16384
    s_nop 0
    buffer_load_dwordx4 v7, s[20:23], s69 offen offset:3072 lds
    v_fmac_f32 v172, v163, v140
    v_fmac_f32 v173, v163, v141
    v_fmac_f32 v166, v162, v135
    v_fmac_f32 v167, v162, v136
    v_fmac_f32 v168, v162, v137
    s_waitcnt lgkmcnt(3)
    v_mfma_f32_32x32x16_bf16 v[64:79], v[24:27], v[16:19], v[64:79]
    ds_read_b64_tr_b16 v[40:41], v12 offset:45056
    ds_read_b64_tr_b16 v[42:43], v12 offset:46080
    v_fmac_f32 v169, v162, v138
    v_fmac_f32 v170, v162, v139
    v_fmac_f32 v171, v162, v140
    v_fmac_f32 v172, v162, v141
    v_fmac_f32 v173, v162, v142
    s_waitcnt lgkmcnt(4)
    v_mfma_f32_32x32x16_bf16 v[80:95], v[24:27], v[20:23], v[80:95]
    ds_read_b128 v[32:35], v11 offset:32768
    ds_read_b128 v[36:39], v11 offset:36864
    v_lshlrev_b32 v152, 16, v148
    v_and_b32 v153, 0xffff0000, v148
    v_lshlrev_b32 v154, 16, v149
    v_and_b32 v155, 0xffff0000, v149
    v_lshlrev_b32 v156, 16, v150
    s_waitcnt lgkmcnt(4)
    v_mfma_f32_32x32x16_bf16 v[96:111], v[28:31], v[16:19], v[96:111]
    ds_read_b64_tr_b16 v[44:45], v13 offset:45056
    ds_read_b64_tr_b16 v[46:47], v13 offset:46080
    s_lshl_b32 s69, s47, 7
    s_add_u32 s69, s69, s55
    s_add_u32 m0, s57, 16384
    s_nop 0
    buffer_load_dwordx4 v2, s[4:7], s69 offen offset:0 lds
    v_and_b32 v157, 0xffff0000, v150
    v_lshlrev_b32 v158, 16, v151
    v_and_b32 v159, 0xffff0000, v151
    v_mul_f32 v166, v166, v152
    v_mul_f32 v167, v167, v153
    v_mfma_f32_32x32x16_bf16 v[112:127], v[28:31], v[20:23], v[112:127]
    s_lshl_b32 s69, s47, 7
    s_add_u32 s69, s69, s55
    s_add_u32 m0, s57, 16384
    s_nop 0
    buffer_load_dwordx4 v3, s[4:7], s69 offen offset:1024 lds
    s_add_u32 s47, s47, 1
    s_cmp_ge_u32 s47, 7
    s_cselect_b32 s47, 0, s47
    v_mul_f32 v168, v168, v154
    v_mul_f32 v169, v169, v155
    v_mul_f32 v170, v170, v156
    v_mul_f32 v171, v171, v157
    v_mul_f32 v172, v172, v158
    v_mul_f32 v173, v173, v159
    v_cvt_pk_bf16_f32 v176, v173, v172
    v_cvt_pk_bf16_f32 v177, v171, v170
    v_cvt_pk_bf16_f32 v178, v169, v168
    v_cvt_pk_bf16_f32 v179, v167, v166
    ds_write_b128 v183, v[176:179]
    s_waitcnt lgkmcnt(0)
    s_waitcnt vmcnt(6)
    s_barrier
    v_mfma_f32_32x32x16_bf16 v[64:79], v[40:43], v[32:35], v[64:79]
    ds_read_b64_tr_b16 v[24:25], v12 offset:0
    ds_read_b64_tr_b16 v[26:27], v12 offset:1024
    s_cmp_ge_u32 s46, 2
    s_cbranch_scc1 L_ncf_6
    s_waitcnt vmcnt(11)
    s_lshl_b32 s64, s2, 2
    s_add_u32 s64, s64, s60
    s_lshl_b32 s64, s64, 7
    s_add_u32 s64, s64, 13893632
    v_mov_b32 v48, s71
    v_mov_b32 v49, s64
    s_mov_b64 exec, 1
    buffer_store_dword v48, v49, s[32:35], 0 offen sc1
    s_mov_b64 exec, -1
L_ncf_6:
    v_mfma_f32_32x32x16_bf16 v[80:95], v[40:43], v[36:39], v[80:95]
    ds_read_b128 v[16:19], v8 offset:0
    ds_read_b128 v[20:23], v8 offset:4096
    ds_read_b128 v[176:179], v182
    v_mfma_f32_32x32x16_bf16 v[96:111], v[44:47], v[32:35], v[96:111]
    ds_read_b64_tr_b16 v[28:29], v13 offset:0
    ds_read_b64_tr_b16 v[30:31], v13 offset:1024
    s_mul_i32 s69, s47, 229376
    s_add_u32 s69, s69, s56
    s_add_u32 m0, s58, 32768
    s_nop 0
    buffer_load_dwordx4 v4, s[20:23], s69 offen offset:0 lds
    v_mfma_f32_32x32x16_bf16 v[112:127], v[44:47], v[36:39], v[112:127]
    s_mul_i32 s69, s47, 229376
    s_add_u32 s69, s69, s56
    s_add_u32 m0, s58, 32768
    s_nop 0
    buffer_load_dwordx4 v5, s[20:23], s69 offen offset:1024 lds
    s_waitcnt lgkmcnt(4)
    v_mfma_f32_32x32x16_bf16 v[64:79], v[24:27], v[16:19], v[64:79]
    ds_read_b64_tr_b16 v[40:41], v12 offset:4096
    ds_read_b64_tr_b16 v[42:43], v12 offset:5120
    s_waitcnt lgkmcnt(4)
    buffer_store_dwordx4 v[176:179], v181, s[32:35], 0 offen sc1
    s_waitcnt lgkmcnt(5)
    v_mfma_f32_32x32x16_bf16 v[80:95], v[24:27], v[20:23], v[80:95]
    ds_read_b128 v[32:35], v9 offset:0
    ds_read_b128 v[36:39], v9 offset:4096
    s_waitcnt lgkmcnt(4)
    v_mfma_f32_32x32x16_bf16 v[96:111], v[28:31], v[16:19], v[96:111]
    ds_read_b64_tr_b16 v[44:45], v13 offset:4096
    ds_read_b64_tr_b16 v[46:47], v13 offset:5120
    s_mul_i32 s69, s47, 229376
    s_add_u32 s69, s69, s56
    s_add_u32 m0, s58, 32768
    s_nop 0
    buffer_load_dwordx4 v6, s[20:23], s69 offen offset:2048 lds
    v_mfma_f32_32x32x16_bf16 v[112:127], v[28:31], v[20:23], v[112:127]
    s_mul_i32 s69, s47, 229376
    s_add_u32 s69, s69, s56
    s_add_u32 m0, s58, 32768
    s_nop 0
    buffer_load_dwordx4 v7, s[20:23], s69 offen offset:3072 lds
    s_waitcnt lgkmcnt(3)
    v_mfma_f32_32x32x16_bf16 v[64:79], v[40:43], v[32:35], v[64:79]
    ds_read_b64_tr_b16 v[24:25], v12 offset:8192
    ds_read_b64_tr_b16 v[26:27], v12 offset:9216
    s_waitcnt lgkmcnt(4)
    v_mfma_f32_32x32x16_bf16 v[80:95], v[40:43], v[36:39], v[80:95]
    ds_read_b128 v[16:19], v10 offset:0
    ds_read_b128 v[20:23], v10 offset:4096
    s_waitcnt lgkmcnt(4)
    v_mfma_f32_32x32x16_bf16 v[96:111], v[44:47], v[32:35], v[96:111]
    ds_read_b64_tr_b16 v[28:29], v13 offset:8192
    ds_read_b64_tr_b16 v[30:31], v13 offset:9216
    s_lshl_b32 s69, s47, 7
    s_add_u32 s69, s69, s55
    s_add_u32 m0, s57, 32768
    s_nop 0
    buffer_load_dwordx4 v2, s[4:7], s69 offen offset:0 lds
    v_mfma_f32_32x32x16_bf16 v[112:127], v[44:47], v[36:39], v[112:127]
    s_lshl_b32 s69, s47, 7
    s_add_u32 s69, s69, s55
    s_add_u32 m0, s57, 32768
    s_nop 0
    buffer_load_dwordx4 v3, s[4:7], s69 offen offset:1024 lds
    s_add_u32 s47, s47, 1
    s_cmp_ge_u32 s47, 7
    s_cselect_b32 s47, 0, s47
    s_waitcnt lgkmcnt(3)
    v_mfma_f32_32x32x16_bf16 v[64:79], v[24:27], v[16:19], v[64:79]
    ds_read_b64_tr_b16 v[40:41], v12 offset:12288
    ds_read_b64_tr_b16 v[42:43], v12 offset:13312
    s_waitcnt lgkmcnt(4)
    v_mfma_f32_32x32x16_bf16 v[80:95], v[24:27], v[20:23], v[80:95]
    ds_read_b128 v[32:35], v11 offset:0
    ds_read_b128 v[36:39], v11 offset:4096
    s_waitcnt lgkmcnt(4)
    v_mfma_f32_32x32x16_bf16 v[96:111], v[28:31], v[16:19], v[96:111]
    ds_read_b64_tr_b16 v[44:45], v13 offset:12288
    ds_read_b64_tr_b16 v[46:47], v13 offset:13312
    v_mfma_f32_32x32x16_bf16 v[112:127], v[28:31], v[20:23], v[112:127]
    s_waitcnt lgkmcnt(0)
    s_waitcnt vmcnt(4)
    s_barrier
    v_mfma_f32_32x32x16_bf16 v[64:79], v[40:43], v[32:35], v[64:79]
    ds_read_b64_tr_b16 v[24:25], v12 offset:16384
    ds_read_b64_tr_b16 v[26:27], v12 offset:17408
    s_cmp_lg_u32 s3, 0
    s_cbranch_scc1 L_nf_7
    v_mov_b32 v48, s71
    s_lshl_b32 s64, s2, 7
    s_add_u32 s64, s64, 13697024
    v_mov_b32 v49, s64
    s_mov_b64 exec, 1
    buffer_store_dword v48, v49, s[32:35], 0 offen sc1
    s_mov_b64 exec, -1
L_nf_7:
    v_mfma_f32_32x32x16_bf16 v[80:95], v[40:43], v[36:39], v[80:95]
    ds_read_b128 v[16:19], v8 offset:16384
    ds_read_b128 v[20:23], v8 offset:20480
    v_mfma_f32_32x32x16_bf16 v[96:111], v[44:47], v[32:35], v[96:111]
    ds_read_b64_tr_b16 v[28:29], v13 offset:16384
    ds_read_b64_tr_b16 v[30:31], v13 offset:17408
    s_mul_i32 s69, s47, 229376
    s_add_u32 s69, s69, s56
    s_add_u32 m0, s58, 0
    s_nop 0
    buffer_load_dwordx4 v4, s[20:23], s69 offen offset:0 lds
    s_mul_i32 s64, s60, 7
    s_add_u32 s64, s64, 224
    v_min_u32 v58, 6, v1
    v_add_u32 v58, s64, v58
    v_lshlrev_b32 v58, 7, v58
    v_add_u32 v58, 13664256, v58
    buffer_load_dword v57, v58, s[32:35], 0 offen sc1
    v_mfma_f32_32x32x16_bf16 v[112:127], v[44:47], v[36:39], v[112:127]
    s_mul_i32 s69, s47, 229376
    s_add_u32 s69, s69, s56
    s_add_u32 m0, s58, 0
    s_nop 0
    buffer_load_dwordx4 v5, s[20:23], s69 offen offset:1024 lds
    s_waitcnt lgkmcnt(3)
    v_mfma_f32_32x32x16_bf16 v[64:79], v[24:27], v[16:19], v[64:79]
    ds_read_b64_tr_b16 v[40:41], v12 offset:20480
    ds_read_b64_tr_b16 v[42:43], v12 offset:21504
    s_waitcnt lgkmcnt(4)
    v_mfma_f32_32x32x16_bf16 v[80:95], v[24:27], v[20:23], v[80:95]
    ds_read_b128 v[32:35], v9 offset:16384
    ds_read_b128 v[36:39], v9 offset:20480
    s_waitcnt lgkmcnt(4)
    v_mfma_f32_32x32x16_bf16 v[96:111], v[28:31], v[16:19], v[96:111]
    ds_read_b64_tr_b16 v[44:45], v13 offset:20480
    ds_read_b64_tr_b16 v[46:47], v13 offset:21504
    s_mul_i32 s69, s47, 229376
    s_add_u32 s69, s69, s56
    s_add_u32 m0, s58, 0
    s_nop 0
    buffer_load_dwordx4 v6, s[20:23], s69 offen offset:2048 lds
    v_mfma_f32_32x32x16_bf16 v[112:127], v[28:31], v[20:23], v[112:127]
    s_mul_i32 s69, s47, 229376
    s_add_u32 s69, s69, s56
    s_add_u32 m0, s58, 0
    s_nop 0
    buffer_load_dwordx4 v7, s[20:23], s69 offen offset:3072 lds
    s_waitcnt lgkmcnt(3)
    v_mfma_f32_32x32x16_bf16 v[64:79], v[40:43], v[32:35], v[64:79]
    ds_read_b64_tr_b16 v[24:25], v12 offset:24576
    ds_read_b64_tr_b16 v[26:27], v12 offset:25600
    s_waitcnt lgkmcnt(4)
    v_mfma_f32_32x32x16_bf16 v[80:95], v[40:43], v[36:39], v[80:95]
    ds_read_b128 v[16:19], v10 offset:16384
    ds_read_b128 v[20:23], v10 offset:20480
    s_waitcnt lgkmcnt(4)
    v_mfma_f32_32x32x16_bf16 v[96:111], v[44:47], v[32:35], v[96:111]
    ds_read_b64_tr_b16 v[28:29], v13 offset:24576
    ds_read_b64_tr_b16 v[30:31], v13 offset:25600
    s_lshl_b32 s69, s47, 7
    s_add_u32 s69, s69, s55
    s_add_u32 m0, s57, 0
    s_nop 0
    buffer_load_dwordx4 v2, s[4:7], s69 offen offset:0 lds
    v_mfma_f32_32x32x16_bf16 v[112:127], v[44:47], v[36:39], v[112:127]
    s_lshl_b32 s69, s47, 7
    s_add_u32 s69, s69, s55
    s_add_u32 m0, s57, 0
    s_nop 0
    buffer_load_dwordx4 v3, s[4:7], s69 offen offset:1024 lds
    s_add_u32 s47, s47, 1
    s_cmp_ge_u32 s47, 7
    s_cselect_b32 s47, 0, s47
    s_waitcnt lgkmcnt(3)
    v_mfma_f32_32x32x16_bf16 v[64:79], v[24:27], v[16:19], v[64:79]
    ds_read_b64_tr_b16 v[40:41], v12 offset:28672
    ds_read_b64_tr_b16 v[42:43], v12 offset:29696
    s_waitcnt lgkmcnt(4)
    v_mfma_f32_32x32x16_bf16 v[80:95], v[24:27], v[20:23], v[80:95]
    ds_read_b128 v[32:35], v11 offset:16384
    ds_read_b128 v[36:39], v11 offset:20480
    s_waitcnt lgkmcnt(4)
    v_mfma_f32_32x32x16_bf16 v[96:111], v[28:31], v[16:19], v[96:111]
    ds_read_b64_tr_b16 v[44:45], v13 offset:28672
    ds_read_b64_tr_b16 v[46:47], v13 offset:29696
    s_mov_b32 s70, 0
    s_waitcnt vmcnt(5)
    s_branch L_chk_10
L_poll_9:
    buffer_load_dword v57, v58, s[32:35], 0 offen sc1
    s_waitcnt vmcnt(0)
L_chk_10:
    v_cmp_ne_u32 vcc, s71, v57
    s_nop 1
    s_cmp_eq_u64 vcc, 0
    s_cbranch_scc1 L_np_8
    s_add_u32 s70, s70, 1
    s_cmp_lt_u32 s70, 100000
    s_cbranch_scc1 L_poll_9
L_np_8:
    v_mfma_f32_32x32x16_bf16 v[112:127], v[28:31], v[20:23], v[112:127]
    s_add_u32 s68, s63, 24576
    buffer_load_dwordx4 v[236:239], v56, s[32:35], s68 offen offset:3072 sc1
    s_waitcnt lgkmcnt(0)
    s_waitcnt vmcnt(8)
    s_barrier
    v_mfma_f32_32x32x16_bf16 v[64:79], v[40:43], v[32:35], v[64:79]
    ds_read_b64_tr_b16 v[24:25], v12 offset:32768
    ds_read_b64_tr_b16 v[26:27], v12 offset:33792
    s_lshl_b32 s64, s51, 3
    s_and_b32 s65, s48, 4
    s_add_u32 s64, s64, s65
    s_lshl_b32 s64, s64, 2
    s_add_u32 s64, s64, s60
    v_bfe_u32 v59, v1, 2, 1
    v_mul_u32_u24 v59, 224, v59
    v_and_b32 v58, 3, v1
    v_lshl_add_u32 v58, v58, 2, v59
    v_add_u32 v58, s64, v58
    s_and_b32 s64, s50, 1
    s_lshl_b32 s64, s64, 1
    s_add_u32 s64, s64, s61
    s_lshl_b32 s64, s64, 3
    s_lshr_b32 s65, s50, 1
    s_lshl_b32 s65, s65, 2
    s_add_u32 s64, s64, s65
    s_and_b32 s65, s48, 3
    s_add_u32 s64, s64, s65
    s_add_u32 s64, s64, 448
    v_mov_b32 v59, s64
    v_cmp_lt_u32 vcc, 7, v1
    s_nop 1
    v_cndmask_b32 v58, v58, v59, vcc
    v_lshlrev_b32 v58, 7, v58
    v_add_u32 v58, 13893632, v58
    buffer_load_dword v57, v58, s[32:35], 0 offen sc1
    v_mfma_f32_32x32x16_bf16 v[80:95], v[40:43], v[36:39], v[80:95]
    ds_read_b128 v[16:19], v8 offset:32768
    ds_read_b128 v[20:23], v8 offset:36864
    s_add_u32 s68, s63, 24576
    buffer_load_dwordx4 v[232:235], v56, s[32:35], s68 offen offset:2048 sc1
    v_mfma_f32_32x32x16_bf16 v[96:111], v[44:47], v[32:35], v[96:111]
    ds_read_b64_tr_b16 v[28:29], v13 offset:32768
    ds_read_b64_tr_b16 v[30:31], v13 offset:33792
    v_mfma_f32_32x32x16_bf16 v[112:127], v[44:47], v[36:39], v[112:127]
    s_add_u32 s68, s63, 24576
    buffer_load_dwordx4 v[228:231], v56, s[32:35], s68 offen offset:1024 sc1
    s_waitcnt lgkmcnt(3)
    v_mfma_f32_32x32x16_bf16 v[64:79], v[24:27], v[16:19], v[64:79]
    ds_read_b64_tr_b16 v[40:41], v12 offset:36864
    ds_read_b64_tr_b16 v[42:43], v12 offset:37888
    s_waitcnt lgkmcnt(4)
    v_mfma_f32_32x32x16_bf16 v[80:95], v[24:27], v[20:23], v[80:95]
    ds_read_b128 v[32:35], v9 offset:32768
    ds_read_b128 v[36:39], v9 offset:36864
    s_waitcnt lgkmcnt(4)
    v_mfma_f32_32x32x16_bf16 v[96:111], v[28:31], v[16:19], v[96:111]
    ds_read_b64_tr_b16 v[44:45], v13 offset:36864
    ds_read_b64_tr_b16 v[46:47], v13 offset:37888
    s_add_u32 s68, s63, 24576
    buffer_load_dwordx4 v[224:227], v56, s[32:35], s68 offen offset:0 sc1
    v_mfma_f32_32x32x16_bf16 v[112:127], v[28:31], v[20:23], v[112:127]
    s_waitcnt lgkmcnt(3)
    v_mfma_f32_32x32x16_bf16 v[64:79], v[40:43], v[32:35], v[64:79]
    ds_read_b64_tr_b16 v[24:25], v12 offset:40960
    ds_read_b64_tr_b16 v[26:27], v12 offset:41984
    s_add_u32 s68, s63, 20480
    buffer_load_dwordx4 v[220:223], v56, s[32:35], s68 offen offset:3072 sc1
    s_waitcnt lgkmcnt(4)
    v_mfma_f32_32x32x16_bf16 v[80:95], v[40:43], v[36:39], v[80:95]
    ds_read_b128 v[16:19], v10 offset:32768
    ds_read_b128 v[20:23], v10 offset:36864
    s_waitcnt lgkmcnt(4)
    v_mfma_f32_32x32x16_bf16 v[96:111], v[44:47], v[32:35], v[96:111]
    ds_read_b64_tr_b16 v[28:29], v13 offset:40960
    ds_read_b64_tr_b16 v[30:31], v13 offset:41984
    s_mov_b32 s70, 0
    s_waitcnt vmcnt(4)
    s_branch L_chk_13
L_poll_12:
    buffer_load_dword v57, v58, s[32:35], 0 offen sc1
    s_waitcnt vmcnt(0)
L_chk_13:
    v_cmp_ne_u32 vcc, s71, v57
    s_nop 1
    s_cmp_eq_u64 vcc, 0
    s_cbranch_scc1 L_np_11
    s_add_u32 s70, s70, 1
    s_cmp_lt_u32 s70, 100000
    s_cbranch_scc1 L_poll_12
L_np_11:
    v_mfma_f32_32x32x16_bf16 v[112:127], v[44:47], v[36:39], v[112:127]
    s_add_u32 s68, s63, 20480
    buffer_load_dwordx4 v[216:219], v56, s[32:35], s68 offen offset:2048 sc1
    s_lshl_b32 s64, s52, 10
    s_lshl_b32 s65, s61, 9
    s_add_u32 s64, s64, s65
    s_add_u32 s64, s64, 12582912
    v_lshlrev_b32 v48, 3, v14
    buffer_load_dwordx2 v[52:53], v48, s[32:35], s64 offen offset:0 sc1
    buffer_load_dwordx2 v[54:55], v48, s[32:35], s64 offen offset:256 sc1
    s_waitcnt lgkmcnt(3)
    v_mfma_f32_32x32x16_bf16 v[64:79], v[24:27], v[16:19], v[64:79]
    ds_read_b64_tr_b16 v[40:41], v12 offset:45056
    ds_read_b64_tr_b16 v[42:43], v12 offset:46080
    s_lshl_b32 s64, s53, 3
    s_lshl_b32 s65, s60, 1
    s_add_u32 s64, s64, s65
    s_lshl_b32 s64, s64, 10
    s_add_u32 s64, s64, 12648448
    v_lshlrev_b32 v48, 2, v14
    v_lshl_add_u32 v48, v15, 9, v48
    s_waitcnt lgkmcnt(4)
    v_mfma_f32_32x32x16_bf16 v[80:95], v[24:27], v[20:23], v[80:95]
    ds_read_b128 v[32:35], v11 offset:32768
    ds_read_b128 v[36:39], v11 offset:36864
    s_add_u32 s68, s63, 20480
    buffer_load_dwordx4 v[212:215], v56, s[32:35], s68 offen offset:1024 sc1
    buffer_load_dword v240, v48, s[32:35], s64 offen offset:0 sc1
    buffer_load_dword v241, v48, s[32:35], s64 offen offset:128 sc1
    s_waitcnt lgkmcnt(4)
    v_mfma_f32_32x32x16_bf16 v[96:111], v[28:31], v[16:19], v[96:111]
    ds_read_b64_tr_b16 v[44:45], v13 offset:45056
    ds_read_b64_tr_b16 v[46:47], v13 offset:46080
    buffer_load_dword v242, v48, s[32:35], s64 offen offset:256 sc1
    buffer_load_dword v243, v48, s[32:35], s64 offen offset:384 sc1
    v_mfma_f32_32x32x16_bf16 v[112:127], v[28:31], v[20:23], v[112:127]
    buffer_load_dword v244, v48, s[32:35], s64 offen offset:1024 sc1
    buffer_load_dword v245, v48, s[32:35], s64 offen offset:1152 sc1
    s_waitcnt lgkmcnt(0)
    s_waitcnt vmcnt(16)
    s_barrier
    v_mfma_f32_32x32x16_bf16 v[64:79], v[40:43], v[32:35], v[64:79]
    ds_read_b64_tr_b16 v[24:25], v12 offset:0
    ds_read_b64_tr_b16 v[26:27], v12 offset:1024
    s_add_u32 s68, s63, 20480
    buffer_load_dwordx4 v[208:211], v56, s[32:35], s68 offen offset:0 sc1
    buffer_load_dword v246, v48, s[32:35], s64 offen offset:1280 sc1
    buffer_load_dword v247, v48, s[32:35], s64 offen offset:1408 sc1
    v_mfma_f32_32x32x16_bf16 v[80:95], v[40:43], v[36:39], v[80:95]
    ds_read_b128 v[16:19], v8 offset:0
    ds_read_b128 v[20:23], v8 offset:4096
    s_and_b32 s64, s3, 3
    s_lshl_b32 s64, s64, 3
    s_sub_u32 s64, 31, s64
    v_min_u32 v58, 8, v1
    v_sub_u32 v58, s64, v58
    v_max_i32 v58, 0, v58
    v_mul_u32_u24 v58, 7, v58
    s_lshr_b32 s64, s2, 5
    v_add_u32 v58, s64, v58
    v_lshlrev_b32 v58, 7, v58
    v_add_u32 v58, 13697024, v58
    buffer_load_dword v57, v58, s[32:35], 0 offen sc1
    v_mfma_f32_32x32x16_bf16 v[96:111], v[44:47], v[32:35], v[96:111]
    ds_read_b64_tr_b16 v[28:29], v13 offset:0
    ds_read_b64_tr_b16 v[30:31], v13 offset:1024
    s_add_u32 s68, s63, 16384
    buffer_load_dwordx4 v[204:207], v56, s[32:35], s68 offen offset:3072 sc1
    s_lshl_b32 s64, s2, 13
    v_lshlrev_b32 v48, 4, v0
    s_lshr_b32 s65, s3, 2
    s_mul_i32 s65, s65, 16720
    s_and_b32 s67, s3, 3
    s_lshl_b32 s66, s67, 10
    s_add_u32 s66, s66, s65
    v_mfma_f32_32x32x16_bf16 v[112:127], v[44:47], v[36:39], v[112:127]
    s_add_u32 m0, s66, 127040
    s_nop 0
    buffer_load_dwordx4 v48, s[16:19], s64 offen offset:0 lds
    s_waitcnt lgkmcnt(3)
    v_mfma_f32_32x32x16_bf16 v[64:79], v[24:27], v[16:19], v[64:79]
    ds_read_b64_tr_b16 v[40:41], v12 offset:4096
    ds_read_b64_tr_b16 v[42:43], v12 offset:5120
    s_add_u32 s68, s63, 16384
    buffer_load_dwordx4 v[200:203], v56, s[32:35], s68 offen offset:2048 sc1
    s_add_u32 m0, s66, 131212
    s_nop 0
    buffer_load_dwordx4 v48, s[16:19], s64 offen offset:4 lds
    s_waitcnt lgkmcnt(4)
    v_mfma_f32_32x32x16_bf16 v[80:95], v[24:27], v[20:23], v[80:95]
    ds_read_b128 v[32:35], v9 offset:0
    ds_read_b128 v[36:39], v9 offset:4096
    s_add_u32 m0, s66, 135368
    s_nop 0
    buffer_load_dwordx4 v48, s[16:19], s64 offen offset:8 lds
    s_waitcnt lgkmcnt(4)
    v_mfma_f32_32x32x16_bf16 v[96:111], v[28:31], v[16:19], v[96:111]
    ds_read_b64_tr_b16 v[44:45], v13 offset:4096
    ds_read_b64_tr_b16 v[46:47], v13 offset:5120
    s_add_u32 m0, s66, 139524
    s_nop 0
    buffer_load_dwordx4 v48, s[16:19], s64 offen offset:12 lds
    v_mfma_f32_32x32x16_bf16 v[112:127], v[28:31], v[20:23], v[112:127]
    s_add_u32 s68, s63, 16384
    buffer_load_dwordx4 v[196:199], v56, s[32:35], s68 offen offset:1024 sc1
    s_mul_i32 s66, s67, 4160
    s_add_u32 s66, s66, s65
    s_add_u32 s66, s66, 127056
    s_cmp_eq_u32 s67, 0
    s_cselect_b32 s65, 16, 0
    s_sub_u32 s66, s66, s65
    s_waitcnt lgkmcnt(3)
    v_mfma_f32_32x32x16_bf16 v[64:79], v[40:43], v[32:35], v[64:79]
    ds_read_b64_tr_b16 v[24:25], v12 offset:8192
    ds_read_b64_tr_b16 v[26:27], v12 offset:9216
    v_mov_b32 v48, 0
    v_mov_b32 v49, 0
    v_mov_b32 v50, 0
    v_mov_b32 v51, 0
    s_sub_u32 s65, s66, 64
    v_lshl_add_u32 v62, v1, 2, s65
    s_waitcnt lgkmcnt(4)
    v_mfma_f32_32x32x16_bf16 v[80:95], v[40:43], v[36:39], v[80:95]
    ds_read_b128 v[16:19], v10 offset:0
    ds_read_b128 v[20:23], v10 offset:4096
    s_add_u32 s68, s63, 16384
    buffer_load_dwordx4 v[192:195], v56, s[32:35], s68 offen offset:0 sc1
    s_lshr_b32 exec_lo, 0xffff, s67
    s_mov_b32 exec_hi, 0
    ds_write_b32 v62, v48
    s_mov_b64 exec, -1
    s_cmp_eq_u32 s67, 0
    s_cbranch_scc1 L_nod0_14
    s_lshl_b32 s65, s67, 2
    s_sub_u32 m0, s66, s65
    s_lshr_b32 s65, s3, 2
    s_lshl_b32 s65, s65, 12
    s_add_u32 s64, s64, s65
    v_lshlrev_b32 v62, 2, v1
    s_bfm_b64 exec, s67, 0
    buffer_load_dword v62, s[16:19], s64 offen lds
    s_mov_b64 exec, -1
L_nod0_14:
    s_waitcnt lgkmcnt(5)
    v_mfma_f32_32x32x16_bf16 v[96:111], v[44:47], v[32:35], v[96:111]
    ds_read_b64_tr_b16 v[28:29], v13 offset:8192
    ds_read_b64_tr_b16 v[30:31], v13 offset:9216
    s_bfe_u32 s64, s3, 0x10001
    s_mul_i32 s64, s64, 9216
    s_mul_i32 s65, s61, 4640
    s_add_u32 s65, s65, s64
    s_add_u32 s65, s65, 20480
    v_add_u32 v62, s65, v56
    v_mfma_f32_32x32x16_bf16 v[112:127], v[44:47], v[36:39], v[112:127]
    s_mov_b64 exec, 0xfffffff
    ds_write_b128 v62, v[48:51]
    s_mov_b64 exec, -1
    v_mov_b32 v62, 34816
    ds_write_b64 v62, v[48:49]
    s_waitcnt lgkmcnt(6)
    v_mfma_f32_32x32x16_bf16 v[64:79], v[24:27], v[16:19], v[64:79]
    ds_read_b64_tr_b16 v[40:41], v12 offset:12288
    ds_read_b64_tr_b16 v[42:43], v12 offset:13312
    s_add_u32 s68, s63, 12288
    buffer_load_dwordx4 v[188:191], v56, s[32:35], s68 offen offset:3072 sc1
    s_waitcnt vmcnt(10)
    v_xor_b32 v248, 0x80000000, v52
    v_lshrrev_b32 v249, 16, v248
    v_or_b32 v248, v248, v249
    s_waitcnt lgkmcnt(7)
    v_mfma_f32_32x32x16_bf16 v[80:95], v[24:27], v[20:23], v[80:95]
    ds_read_b128 v[32:35], v11 offset:0
    ds_read_b128 v[36:39], v11 offset:4096
    v_mov_b32 v249, v248
    v_mov_b32 v250, v248
    v_mov_b32 v251, v248
    s_waitcnt lgkmcnt(6)
    v_mfma_f32_32x32x16_bf16 v[96:111], v[28:31], v[16:19], v[96:111]
    ds_read_b64_tr_b16 v[44:45], v13 offset:12288
    ds_read_b64_tr_b16 v[46:47], v13 offset:13312
    s_add_u32 s68, s63, 12288
    buffer_load_dwordx4 v[184:187], v56, s[32:35], s68 offen offset:2048 sc1
    v_xor_b32 v252, 0x80000000, v54
    v_lshrrev_b32 v253, 16, v252
    v_or_b32 v252, v252, v253
    v_mfma_f32_32x32x16_bf16 v[112:127], v[28:31], v[20:23], v[112:127]
    v_mov_b32 v253, v252
    v_mov_b32 v254, v252
    v_mov_b32 v255, v252
    s_waitcnt lgkmcnt(3)
    v_mfma_f32_32x32x16_bf16 v[64:79], v[40:43], v[32:35], v[64:79]
    s_lshl_b32 s64, s2, 13
    v_lshlrev_b32 v48, 4, v0
    v_and_b32 v49, 255, v0
    v_cmp_eq_u32 vcc, 255, v49
    v_add_u32 v49, 16, v48
    v_mov_b32 v50, 0x7fffff00
    v_cndmask_b32 v49, v49, v50, vcc
    s_waitcnt lgkmcnt(2)
    v_mfma_f32_32x32x16_bf16 v[80:95], v[40:43], v[36:39], v[80:95]
    s_mov_b32 s70, 0
    s_waitcnt vmcnt(10)
    s_branch L_chk_17
L_poll_16:
    buffer_load_dword v57, v58, s[32:35], 0 offen sc1
    s_waitcnt vmcnt(0)
L_chk_17:
    v_cmp_ne_u32 vcc, s71, v57
    s_nop 1
    s_cmp_eq_u64 vcc, 0
    s_cbranch_scc1 L_np_15
    s_add_u32 s70, s70, 1
    s_cmp_lt_u32 s70, 100000
    s_cbranch_scc1 L_poll_16
L_np_15:
    buffer_load_dwordx4 v[60:63], v48, s[32:35], s64 offen sc1
    buffer_load_dword v59, v49, s[32:35], s64 offen sc1
    s_waitcnt lgkmcnt(0)
    v_mfma_f32_32x32x16_bf16 v[96:111], v[44:47], v[32:35], v[96:111]
    v_mfma_f32_32x32x16_bf16 v[112:127], v[44:47], v[36:39], v[112:127]
    s_lshl_b32 s64, s2, 2
    s_load_dword s62, s[44:45], s64
    s_lshl_b32 s64, s52, 2
    s_lshl_b32 s65, s61, 1
    s_add_u32 s64, s64, s65
    s_mul_i32 s64, s64, 112
    s_lshl_b32 s65, s53, 3
    s_add_u32 s64, s64, s65
    s_lshl_b32 s65, s60, 1
    s_add_u32 s64, s64, s65
    s_lshl_b32 s64, s64, 10
    s_add_u32 s55, s64, 2097152
    s_add_u32 s56, s55, 114688
    v_and_b32 v2, 15, v1
    v_lshrrev_b32 v3, 4, v1
    v_and_b32 v4, 1, v1
    v_add_u32 v7, 1, v2
    v_and_b32 v5, 3, v7
    v_lshrrev_b32 v7, 2, v7
    v_cmp_eq_u32 vcc, 0, v5
    v_mul_u32_u24 v5, 4160, v5
    v_add_u32 v7, v7, v3
    v_lshl_add_u32 v5, v7, 4, v5
    v_cndmask_b32 v7, 0, 16, vcc
    v_sub_u32 v5, v5, v7
    s_mul_i32 s64, s61, 16720
    s_lshl_b32 s66, s60, 7
    s_add_u32 s64, s64, s66
    s_add_u32 s64, s64, 126992
    v_add_u32 v5, s64, v5
    v_mul_u32_u24 v6, 4640, v4
    v_lshl_add_u32 v6, v3, 4, v6
    v_lshrrev_b32 v7, 1, v2
    v_lshlrev_b32 v13, 6, v7
    v_sub_u32 v6, v6, v13
    s_mul_i32 s65, s61, 9216
    s_add_u32 s64, s65, s66
    s_add_u32 s64, s64, 16832
    v_add_u32 v6, s64, v6
    s_lshl_b32 s66, s60, 10
    s_sub_u32 s66, s65, s66
    s_add_u32 s66, s66, 25104
    v_sub_u32 v13, s66, v56
    v_mfma_f32_32x32x16_bf16 v[64:79], v[240:243], v[248:251], v[64:79]
    v_mfma_f32_32x32x16_bf16 v[80:95], v[240:243], v[252:255], v[80:95]
    v_mfma_f32_32x32x16_bf16 v[96:111], v[244:247], v[248:251], v[96:111]
    v_mfma_f32_32x32x16_bf16 v[112:127], v[244:247], v[252:255], v[112:127]
    v_mul_f32 v24, 0xbfb8aa3b, v53
    v_mul_f32 v26, v53, v53
    v_mov_b32 v25, v24
    v_rcp_f32 v26, v26
    s_nop 0
    v_mov_b32 v27, v26
    v_mul_f32 v28, 0xbfb8aa3b, v55
    v_mul_f32 v30, v55, v55
    v_mov_b32 v29, v28
    v_rcp_f32 v30, v30
    s_nop 0
    v_mov_b32 v31, v30
    v_pk_mul_f32 v[16:17], v[64:65], v[24:25]
    v_pk_mul_f32 v[18:19], v[66:67], v[24:25]
    v_pk_mul_f32 v[20:21], v[68:69], v[24:25]
    v_pk_mul_f32 v[22:23], v[70:71], v[24:25]
    v_exp_f32 v16, v16
    v_exp_f32 v17, v17
    v_exp_f32 v18, v18
    v_exp_f32 v19, v19
    v_exp_f32 v20, v20
    v_exp_f32 v21, v21
    v_exp_f32 v22, v22
    v_exp_f32 v23, v23
    v_pk_mul_f32 v[64:65], v[64:65], v[72:73]
    v_pk_mul_f32 v[66:67], v[66:67], v[74:75]
    v_pk_mul_f32 v[68:69], v[68:69], v[76:77]
    v_pk_mul_f32 v[70:71], v[70:71], v[78:79]
    v_pk_fma_f32 v[16:17], v[16:17], v[26:27], v[26:27]
    v_pk_fma_f32 v[18:19], v[18:19], v[26:27], v[26:27]
    v_pk_fma_f32 v[20:21], v[20:21], v[26:27], v[26:27]
    v_pk_fma_f32 v[22:23], v[22:23], v[26:27], v[26:27]
    v_rcp_f32 v16, v16
    v_rcp_f32 v17, v17
    v_rcp_f32 v18, v18
    v_rcp_f32 v19, v19
    v_rcp_f32 v20, v20
    v_rcp_f32 v21, v21
    v_rcp_f32 v22, v22
    v_rcp_f32 v23, v23
    v_pk_mul_f32 v[64:65], v[64:65], v[16:17]
    v_pk_mul_f32 v[66:67], v[66:67], v[18:19]
    v_pk_mul_f32 v[68:69], v[68:69], v[20:21]
    v_pk_mul_f32 v[70:71], v[70:71], v[22:23]
    v_cvt_pk_bf16_f32 v72, v64, v65
    v_cvt_pk_bf16_f32 v73, v66, v67
    v_cvt_pk_bf16_f32 v74, v68, v69
    v_cvt_pk_bf16_f32 v75, v70, v71
    buffer_store_dwordx4 v[72:75], v56, s[32:35], s55 offen offset:0 sc1
    v_pk_mul_f32 v[16:17], v[80:81], v[28:29]
    v_pk_mul_f32 v[18:19], v[82:83], v[28:29]
    v_pk_mul_f32 v[20:21], v[84:85], v[28:29]
    v_pk_mul_f32 v[22:23], v[86:87], v[28:29]
    v_exp_f32 v16, v16
    v_exp_f32 v17, v17
    v_exp_f32 v18, v18
    v_exp_f32 v19, v19
    v_exp_f32 v20, v20
    v_exp_f32 v21, v21
    v_exp_f32 v22, v22
    v_exp_f32 v23, v23
    v_pk_mul_f32 v[80:81], v[80:81], v[88:89]
    v_pk_mul_f32 v[82:83], v[82:83], v[90:91]
    v_pk_mul_f32 v[84:85], v[84:85], v[92:93]
    v_pk_mul_f32 v[86:87], v[86:87], v[94:95]
    v_pk_fma_f32 v[16:17], v[16:17], v[30:31], v[30:31]
    v_pk_fma_f32 v[18:19], v[18:19], v[30:31], v[30:31]
    v_pk_fma_f32 v[20:21], v[20:21], v[30:31], v[30:31]
    v_pk_fma_f32 v[22:23], v[22:23], v[30:31], v[30:31]
    v_rcp_f32 v16, v16
    v_rcp_f32 v17, v17
    v_rcp_f32 v18, v18
    v_rcp_f32 v19, v19
    v_rcp_f32 v20, v20
    v_rcp_f32 v21, v21
    v_rcp_f32 v22, v22
    v_rcp_f32 v23, v23
    v_pk_mul_f32 v[80:81], v[80:81], v[16:17]
    v_pk_mul_f32 v[82:83], v[82:83], v[18:19]
    v_pk_mul_f32 v[84:85], v[84:85], v[20:21]
    v_pk_mul_f32 v[86:87], v[86:87], v[22:23]
    v_cvt_pk_bf16_f32 v88, v80, v81
    v_cvt_pk_bf16_f32 v89, v82, v83
    v_cvt_pk_bf16_f32 v90, v84, v85
    v_cvt_pk_bf16_f32 v91, v86, v87
    buffer_store_dwordx4 v[88:91], v56, s[32:35], s56 offen offset:0 sc1
    v_pk_mul_f32 v[16:17], v[96:97], v[24:25]
    v_pk_mul_f32 v[18:19], v[98:99], v[24:25]
    v_pk_mul_f32 v[20:21], v[100:101], v[24:25]
    v_pk_mul_f32 v[22:23], v[102:103], v[24:25]
    v_exp_f32 v16, v16
    v_exp_f32 v17, v17
    v_exp_f32 v18, v18
    v_exp_f32 v19, v19
    v_exp_f32 v20, v20
    v_exp_f32 v21, v21
    v_exp_f32 v22, v22
    v_exp_f32 v23, v23
    v_pk_mul_f32 v[96:97], v[96:97], v[104:105]
    v_pk_mul_f32 v[98:99], v[98:99], v[106:107]
    v_pk_mul_f32 v[100:101], v[100:101], v[108:109]
    v_pk_mul_f32 v[102:103], v[102:103], v[110:111]
    v_pk_fma_f32 v[16:17], v[16:17], v[26:27], v[26:27]
    v_pk_fma_f32 v[18:19], v[18:19], v[26:27], v[26:27]
    v_pk_fma_f32 v[20:21], v[20:21], v[26:27], v[26:27]
    v_pk_fma_f32 v[22:23], v[22:23], v[26:27], v[26:27]
    v_rcp_f32 v16, v16
    v_rcp_f32 v17, v17
    v_rcp_f32 v18, v18
    v_rcp_f32 v19, v19
    v_rcp_f32 v20, v20
    v_rcp_f32 v21, v21
    v_rcp_f32 v22, v22
    v_rcp_f32 v23, v23
    v_pk_mul_f32 v[96:97], v[96:97], v[16:17]
    v_pk_mul_f32 v[98:99], v[98:99], v[18:19]
    v_pk_mul_f32 v[100:101], v[100:101], v[20:21]
    v_pk_mul_f32 v[102:103], v[102:103], v[22:23]
    v_cvt_pk_bf16_f32 v104, v96, v97
    v_cvt_pk_bf16_f32 v105, v98, v99
    v_cvt_pk_bf16_f32 v106, v100, v101
    v_cvt_pk_bf16_f32 v107, v102, v103
    buffer_store_dwordx4 v[104:107], v56, s[32:35], s55 offen offset:1024 sc1
    v_pk_mul_f32 v[16:17], v[112:113], v[28:29]
    v_pk_mul_f32 v[18:19], v[114:115], v[28:29]
    v_pk_mul_f32 v[20:21], v[116:117], v[28:29]
    v_pk_mul_f32 v[22:23], v[118:119], v[28:29]
    v_exp_f32 v16, v16
    v_exp_f32 v17, v17
    v_exp_f32 v18, v18
    v_exp_f32 v19, v19
    v_exp_f32 v20, v20
    v_exp_f32 v21, v21
    v_exp_f32 v22, v22
    v_exp_f32 v23, v23
    v_pk_mul_f32 v[112:113], v[112:113], v[120:121]
    v_pk_mul_f32 v[114:115], v[114:115], v[122:123]
    v_pk_mul_f32 v[116:117], v[116:117], v[124:125]
    v_pk_mul_f32 v[118:119], v[118:119], v[126:127]
    v_pk_fma_f32 v[16:17], v[16:17], v[30:31], v[30:31]
    v_pk_fma_f32 v[18:19], v[18:19], v[30:31], v[30:31]
    v_pk_fma_f32 v[20:21], v[20:21], v[30:31], v[30:31]
    v_pk_fma_f32 v[22:23], v[22:23], v[30:31], v[30:31]
    v_rcp_f32 v16, v16
    v_rcp_f32 v17, v17
    v_rcp_f32 v18, v18
    v_rcp_f32 v19, v19
    v_rcp_f32 v20, v20
    v_rcp_f32 v21, v21
    v_rcp_f32 v22, v22
    v_rcp_f32 v23, v23
    v_pk_mul_f32 v[112:113], v[112:113], v[16:17]
    v_pk_mul_f32 v[114:115], v[114:115], v[18:19]
    v_pk_mul_f32 v[116:117], v[116:117], v[20:21]
    v_pk_mul_f32 v[118:119], v[118:119], v[22:23]
    v_cvt_pk_bf16_f32 v120, v112, v113
    v_cvt_pk_bf16_f32 v121, v114, v115
    v_cvt_pk_bf16_f32 v122, v116, v117
    v_cvt_pk_bf16_f32 v123, v118, v119
    buffer_store_dwordx4 v[120:123], v56, s[32:35], s56 offen offset:1024 sc1
    v_lshrrev_b32 v57, 8, v0
    v_mul_u32_u24 v57, 9216, v57
    v_and_b32 v58, 255, v0
    v_lshl_add_u32 v57, v58, 4, v57
    s_waitcnt vmcnt(4)
    v_alignbit_b32 v48, v61, v60, 16
    v_alignbit_b32 v49, v62, v61, 16
    v_alignbit_b32 v50, v63, v62, 16
    v_alignbit_b32 v51, v59, v63, 16
    ds_write_b128 v57, v[60:63] offset:21024
    ds_write_b128 v57, v[48:51] offset:16384
    s_waitcnt lgkmcnt(0)
    s_barrier
    ds_read_b128 v[240:243], v6 offset:3584
    ds_read_b128 v[244:247], v5 offset:3584
    ds_read_b128 v[248:251], v5 offset:3072
    ds_read_b128 v[252:255], v6 offset:3072
    ds_read_b128 v[64:67], v5 offset:2560
    ds_read_b128 v[68:71], v6 offset:2560
    ds_read_b128 v[72:75], v5 offset:2048
    ds_read_b128 v[76:79], v6 offset:2048
    ds_read_b128 v[80:83], v5 offset:1536
    ds_read_b128 v[84:87], v6 offset:1536
    ds_read_b128 v[88:91], v5 offset:1024
    ds_read_b128 v[92:95], v6 offset:1024
    ds_read_b128 v[96:99], v5 offset:512
    ds_read_b128 v[100:103], v6 offset:512
    s_cmp_lt_u32 s3, 4
    s_cbranch_scc1 L_ah_18
    s_waitcnt vmcnt(0)
    v_mov_b32 v8, 34816
    v_mov_b32 v9, 1
    s_mov_b64 exec, 1
    ds_add_rtn_u32 v9, v8, v9
    s_mov_b64 exec, -1
    s_waitcnt lgkmcnt(0)
    v_readfirstlane_b32 s64, v9
    s_nop 0
    s_cmp_lg_u32 s64, 7
    s_cbranch_scc1 L_na_19
    v_mov_b32 v8, s71
    s_lshl_b32 s64, s2, 7
    s_add_u32 s64, s64, 13729792
    v_mov_b32 v9, s64
    s_mov_b64 exec, 1
    buffer_store_dword v8, v9, s[32:35], 0 offen sc1
    s_mov_b64 exec, -1
L_na_19:
L_ah_18:
    s_waitcnt lgkmcnt(12)
    v_mfma_f32_16x16x32_bf16 v[44:47], v[244:247], v[240:243], 0
    ds_read_b128 v[104:107], v5 offset:0
    s_waitcnt lgkmcnt(12)
    v_mfma_f32_16x16x32_bf16 v[40:43], v[248:251], v[240:243], 0
    ds_read_b128 v[108:111], v6 offset:0
    s_waitcnt lgkmcnt(12)
    v_mfma_f32_16x16x32_bf16 v[44:47], v[248:251], v[252:255], v[44:47]
    ds_read_b128 v[112:115], v6 offset:3648
    s_waitcnt lgkmcnt(12)
    v_mfma_f32_16x16x32_bf16 v[36:39], v[64:67], v[240:243], 0
    ds_read_b128 v[116:119], v5 offset:3648
    v_mfma_f32_16x16x32_bf16 v[40:43], v[64:67], v[252:255], v[40:43]
    ds_read_b128 v[120:123], v5 offset:3136
    s_waitcnt lgkmcnt(13)
    v_mfma_f32_16x16x32_bf16 v[44:47], v[64:67], v[68:71], v[44:47]
    ds_read_b128 v[124:127], v6 offset:3136
    s_waitcnt lgkmcnt(13)
    v_mfma_f32_16x16x32_bf16 v[32:35], v[72:75], v[240:243], 0
    ds_read_b128 v[244:247], v5 offset:2624
    v_mfma_f32_16x16x32_bf16 v[36:39], v[72:75], v[252:255], v[36:39]
    ds_read_b128 v[248:251], v6 offset:2624
    v_mfma_f32_16x16x32_bf16 v[40:43], v[72:75], v[68:71], v[40:43]
    ds_read_b128 v[64:67], v5 offset:2112
    s_waitcnt lgkmcnt(15)
    v_mfma_f32_16x16x32_bf16 v[44:47], v[72:75], v[76:79], v[44:47]
    ds_read_b128 v[72:75], v6 offset:2112
    s_waitcnt lgkmcnt(15)
    v_mfma_f32_16x16x32_bf16 v[28:31], v[80:83], v[240:243], 0
    v_mfma_f32_16x16x32_bf16 v[32:35], v[80:83], v[252:255], v[32:35]
    v_mfma_f32_16x16x32_bf16 v[36:39], v[80:83], v[68:71], v[36:39]
    v_mfma_f32_16x16x32_bf16 v[40:43], v[80:83], v[76:79], v[40:43]
    s_waitcnt lgkmcnt(14)
    v_mfma_f32_16x16x32_bf16 v[44:47], v[80:83], v[84:87], v[44:47]
    ds_read_b128 v[80:83], v5 offset:1600
    s_waitcnt lgkmcnt(14)
    v_mfma_f32_16x16x32_bf16 v[24:27], v[88:91], v[240:243], 0
    v_mfma_f32_16x16x32_bf16 v[28:31], v[88:91], v[252:255], v[28:31]
    v_mfma_f32_16x16x32_bf16 v[32:35], v[88:91], v[68:71], v[32:35]
    v_mfma_f32_16x16x32_bf16 v[36:39], v[88:91], v[76:79], v[36:39]
    v_mfma_f32_16x16x32_bf16 v[40:43], v[88:91], v[84:87], v[40:43]
    s_waitcnt lgkmcnt(13)
    v_mfma_f32_16x16x32_bf16 v[44:47], v[88:91], v[92:95], v[44:47]
    ds_read_b128 v[88:91], v6 offset:1600
    s_waitcnt lgkmcnt(13)
    v_mfma_f32_16x16x32_bf16 v[20:23], v[96:99], v[240:243], 0
    v_mfma_f32_16x16x32_bf16 v[24:27], v[96:99], v[252:255], v[24:27]
    v_mfma_f32_16x16x32_bf16 v[28:31], v[96:99], v[68:71], v[28:31]
    v_mfma_f32_16x16x32_bf16 v[32:35], v[96:99], v[76:79], v[32:35]
    v_mfma_f32_16x16x32_bf16 v[36:39], v[96:99], v[84:87], v[36:39]
    v_mfma_f32_16x16x32_bf16 v[40:43], v[96:99], v[92:95], v[40:43]
    s_waitcnt lgkmcnt(12)
    v_mfma_f32_16x16x32_bf16 v[44:47], v[96:99], v[100:103], v[44:47]
    ds_read_b128 v[96:99], v5 offset:1088
    s_waitcnt lgkmcnt(12)
    v_mfma_f32_16x16x32_bf16 v[16:19], v[104:107], v[240:243], 0
    ds_read_b128 v[240:243], v6 offset:1088
    v_mfma_f32_16x16x32_bf16 v[20:23], v[104:107], v[252:255], v[20:23]
    ds_read_b128 v[252:255], v5 offset:576
    v_mfma_f32_16x16x32_bf16 v[24:27], v[104:107], v[68:71], v[24:27]
    ds_read_b128 v[68:71], v6 offset:576
    v_mfma_f32_16x16x32_bf16 v[28:31], v[104:107], v[76:79], v[28:31]
    ds_read_b128 v[76:79], v5 offset:64
    v_mfma_f32_16x16x32_bf16 v[32:35], v[104:107], v[84:87], v[32:35]
    ds_read_b128 v[84:87], v6 offset:64
    v_mfma_f32_16x16x32_bf16 v[36:39], v[104:107], v[92:95], v[36:39]
    v_mfma_f32_16x16x32_bf16 v[40:43], v[104:107], v[100:103], v[40:43]
    s_waitcnt lgkmcnt(15)
    v_mfma_f32_16x16x32_bf16 v[44:47], v[104:107], v[108:111], v[44:47]
    s_waitcnt lgkmcnt(14)
    v_mfma_f32_16x16x32_bf16 v[44:47], v[116:119], v[112:115], v[44:47]
    s_waitcnt lgkmcnt(13)
    v_mfma_f32_16x16x32_bf16 v[40:43], v[120:123], v[112:115], v[40:43]
    s_waitcnt lgkmcnt(12)
    v_mfma_f32_16x16x32_bf16 v[44:47], v[120:123], v[124:127], v[44:47]
    s_waitcnt lgkmcnt(11)
    v_mfma_f32_16x16x32_bf16 v[36:39], v[244:247], v[112:115], v[36:39]
    v_mfma_f32_16x16x32_bf16 v[40:43], v[244:247], v[124:127], v[40:43]
    s_cmp_ge_u32 s3, 4
    s_cbranch_scc1 L_al_20
    s_waitcnt vmcnt(0)
    v_mov_b32 v8, 34816
    v_mov_b32 v9, 1
    s_mov_b64 exec, 1
    ds_add_rtn_u32 v9, v8, v9
    s_mov_b64 exec, -1
    s_waitcnt lgkmcnt(0)
    v_readfirstlane_b32 s64, v9
    s_nop 0
    s_cmp_lg_u32 s64, 7
    s_cbranch_scc1 L_na_21
    v_mov_b32 v8, s71
    s_lshl_b32 s64, s2, 7
    s_add_u32 s64, s64, 13729792
    v_mov_b32 v9, s64
    s_mov_b64 exec, 1
    buffer_store_dword v8, v9, s[32:35], 0 offen sc1
    s_mov_b64 exec, -1
L_na_21:
L_al_20:
    s_waitcnt lgkmcnt(10)
    v_mfma_f32_16x16x32_bf16 v[44:47], v[244:247], v[248:251], v[44:47]
    s_waitcnt lgkmcnt(9)
    v_mfma_f32_16x16x32_bf16 v[32:35], v[64:67], v[112:115], v[32:35]
    s_add_u32 s68, s63, 0
    buffer_load_dwordx4 v[128:131], v56, s[32:35], s68 offen offset:0 sc1
    v_mfma_f32_16x16x32_bf16 v[36:39], v[64:67], v[124:127], v[36:39]
    v_mfma_f32_16x16x32_bf16 v[40:43], v[64:67], v[248:251], v[40:43]
    s_add_u32 s68, s63, 0
    buffer_load_dwordx4 v[132:135], v56, s[32:35], s68 offen offset:1024 sc1
    s_waitcnt lgkmcnt(8)
    v_mfma_f32_16x16x32_bf16 v[44:47], v[64:67], v[72:75], v[44:47]
    s_waitcnt lgkmcnt(7)
    v_mfma_f32_16x16x32_bf16 v[28:31], v[80:83], v[112:115], v[28:31]
    s_add_u32 s68, s63, 0
    buffer_load_dwordx4 v[136:139], v56, s[32:35], s68 offen offset:2048 sc1
    v_mfma_f32_16x16x32_bf16 v[32:35], v[80:83], v[124:127], v[32:35]
    v_mfma_f32_16x16x32_bf16 v[36:39], v[80:83], v[248:251], v[36:39]
    s_add_u32 s68, s63, 0
    buffer_load_dwordx4 v[140:143], v56, s[32:35], s68 offen offset:3072 sc1
    v_mfma_f32_16x16x32_bf16 v[40:43], v[80:83], v[72:75], v[40:43]
    s_waitcnt lgkmcnt(6)
    v_mfma_f32_16x16x32_bf16 v[44:47], v[80:83], v[88:91], v[44:47]
    s_add_u32 s68, s63, 4096
    buffer_load_dwordx4 v[144:147], v56, s[32:35], s68 offen offset:0 sc1
    s_waitcnt lgkmcnt(5)
    v_mfma_f32_16x16x32_bf16 v[24:27], v[96:99], v[112:115], v[24:27]
    v_mfma_f32_16x16x32_bf16 v[28:31], v[96:99], v[124:127], v[28:31]
    s_add_u32 s68, s63, 4096
    buffer_load_dwordx4 v[148:151], v56, s[32:35], s68 offen offset:1024 sc1
    v_mfma_f32_16x16x32_bf16 v[32:35], v[96:99], v[248:251], v[32:35]
    v_mfma_f32_16x16x32_bf16 v[36:39], v[96:99], v[72:75], v[36:39]
    s_add_u32 s68, s63, 4096
    buffer_load_dwordx4 v[152:155], v56, s[32:35], s68 offen offset:2048 sc1
    v_mfma_f32_16x16x32_bf16 v[40:43], v[96:99], v[88:91], v[40:43]
    s_waitcnt lgkmcnt(4)
    v_mfma_f32_16x16x32_bf16 v[44:47], v[96:99], v[240:243], v[44:47]
    s_add_u32 s68, s63, 4096
    buffer_load_dwordx4 v[156:159], v56, s[32:35], s68 offen offset:3072 sc1
    s_waitcnt lgkmcnt(3)
    v_mfma_f32_16x16x32_bf16 v[20:23], v[252:255], v[112:115], v[20:23]
    v_mfma_f32_16x16x32_bf16 v[24:27], v[252:255], v[124:127], v[24:27]
    s_add_u32 s68, s63, 8192
    buffer_load_dwordx4 v[160:163], v56, s[32:35], s68 offen offset:0 sc1
    v_mfma_f32_16x16x32_bf16 v[28:31], v[252:255], v[248:251], v[28:31]
    v_mfma_f32_16x16x32_bf16 v[32:35], v[252:255], v[72:75], v[32:35]
    s_add_u32 s68, s63, 8192
    buffer_load_dwordx4 v[164:167], v56, s[32:35], s68 offen offset:1024 sc1
    s_bfe_u32 s64, s54, 0x20001
    s_mul_i32 s64, s64, 56
    s_lshr_b32 s65, s54, 3
    s_add_u32 s64, s64, s65
    s_and_b32 s65, s60, 1
    s_mul_i32 s65, s65, 24
    s_add_u32 s64, s64, s65
    s_and_b32 s65, s3, 4
    s_add_u32 s64, s64, s65
    v_and_b32 v58, 3, v1
    v_lshl_add_u32 v58, v58, 3, s64
    v_lshlrev_b32 v58, 7, v58
    v_add_u32 v58, 13729792, v58
    buffer_load_dword v57, v58, s[32:35], 0 offen sc1
    v_mfma_f32_16x16x32_bf16 v[36:39], v[252:255], v[88:91], v[36:39]
    v_mfma_f32_16x16x32_bf16 v[40:43], v[252:255], v[240:243], v[40:43]
    s_add_u32 s68, s63, 8192
    buffer_load_dwordx4 v[168:171], v56, s[32:35], s68 offen offset:2048 sc1
    s_waitcnt lgkmcnt(2)
    v_mfma_f32_16x16x32_bf16 v[44:47], v[252:255], v[68:71], v[44:47]
    s_waitcnt lgkmcnt(1)
    v_mfma_f32_16x16x32_bf16 v[16:19], v[76:79], v[112:115], v[16:19]
    s_add_u32 s68, s63, 8192
    buffer_load_dwordx4 v[172:175], v56, s[32:35], s68 offen offset:3072 sc1
    v_mfma_f32_16x16x32_bf16 v[20:23], v[76:79], v[124:127], v[20:23]
    v_mfma_f32_16x16x32_bf16 v[24:27], v[76:79], v[248:251], v[24:27]
    s_add_u32 s68, s63, 12288
    buffer_load_dwordx4 v[176:179], v56, s[32:35], s68 offen offset:0 sc1
    v_mfma_f32_16x16x32_bf16 v[28:31], v[76:79], v[72:75], v[28:31]
    v_mfma_f32_16x16x32_bf16 v[32:35], v[76:79], v[88:91], v[32:35]
    s_add_u32 s68, s63, 12288
    buffer_load_dwordx4 v[180:183], v56, s[32:35], s68 offen offset:1024 sc1
    v_mfma_f32_16x16x32_bf16 v[36:39], v[76:79], v[240:243], v[36:39]
    v_mfma_f32_16x16x32_bf16 v[40:43], v[76:79], v[68:71], v[40:43]
    s_waitcnt lgkmcnt(0)
    v_mfma_f32_16x16x32_bf16 v[44:47], v[76:79], v[84:87], v[44:47]
    ds_read_b128 v[8:11], v13
    s_mul_i32 s64, s3, 8704
    s_add_u32 s64, s64, 49152
    v_mul_u32_u24 v12, 544, v4
    v_lshl_add_u32 v12, v7, 6, v12
    v_lshl_add_u32 v12, v3, 4, v12
    v_add_u32 v12, s64, v12
    ds_write_b128 v12, v[16:19] offset:0
    ds_write_b128 v12, v[20:23] offset:1088
    ds_write_b128 v12, v[24:27] offset:2176
    ds_write_b128 v12, v[28:31] offset:3264
    ds_write_b128 v12, v[32:35] offset:4352
    ds_write_b128 v12, v[36:39] offset:5440
    ds_write_b128 v12, v[40:43] offset:6528
    ds_write_b128 v12, v[44:47] offset:7616
    v_mul_u32_u24 v12, 1088, v15
    v_lshl_add_u32 v12, v14, 4, v12
    s_mul_i32 s64, s60, 2176
    s_mul_i32 s65, s61, 8704
    s_add_u32 s64, s64, s65
    s_add_u32 s64, s64, 49152
    v_add_u32 v12, s64, v12
    s_lshl_b32 s57, s3, 12
    s_lshl_b32 s58, s60, 13
    s_cmp_eq_u32 s60, 2
    s_cselect_b32 s58, 36864, s58
    s_cmp_eq_u32 s60, 3
    s_cselect_b32 s58, 118784, s58
    s_mov_b32 s70, 0
    s_waitcnt vmcnt(4)
    s_branch L_chk_24
L_poll_23:
    buffer_load_dword v57, v58, s[32:35], 0 offen sc1
    s_waitcnt vmcnt(0)
L_chk_24:
    v_cmp_ne_u32 vcc, s71, v57
    s_nop 1
    s_cmp_eq_u64 vcc, 0
    s_cbranch_scc1 L_np_22
    s_add_u32 s70, s70, 1
    s_cmp_lt_u32 s70, 100000
    s_cbranch_scc1 L_poll_23
L_np_22:
    s_add_u32 s69, s59, 0
    s_lshl_b32 s68, s61, 12
    s_add_u32 m0, s68, s58
    s_nop 0
    buffer_load_dwordx4 v56, s[32:35], s69 offen offset:0 sc1 lds
    buffer_load_dwordx4 v56, s[32:35], s69 offen offset:1024 sc1 lds
    buffer_load_dwordx4 v56, s[32:35], s69 offen offset:2048 sc1 lds
    buffer_load_dwordx4 v56, s[32:35], s69 offen offset:3072 sc1 lds
    s_waitcnt lgkmcnt(0)
    s_lshl_b32 s64, s62, 16
    s_and_b32 s65, s62, 0xffff0000
    s_cmp_eq_u32 s61, 1
    s_cselect_b32 s62, s65, s64
    s_barrier
    ds_read_b128 v[64:67], v12 offset:0
    ds_read_b128 v[68:71], v12 offset:544
    ds_read_b128 v[72:75], v12 offset:17408
    ds_read_b128 v[76:79], v12 offset:17952
    ds_read_b128 v[80:83], v12 offset:34816
    ds_read_b128 v[84:87], v12 offset:35360
    ds_read_b128 v[88:91], v12 offset:52224
    ds_read_b128 v[92:95], v12 offset:52768
    s_add_u32 s69, s59, 4096
    s_add_u32 m0, s57, 126976
    s_nop 0
    buffer_load_dwordx4 v56, s[32:35], s69 offen offset:0 sc1 lds
    buffer_load_dwordx4 v56, s[32:35], s69 offen offset:1024 sc1 lds
    buffer_load_dwordx4 v56, s[32:35], s69 offen offset:2048 sc1 lds
    buffer_load_dwordx4 v56, s[32:35], s69 offen offset:3072 sc1 lds
    v_lshlrev_b32 v20, 16, v8
    v_and_b32 v21, 0xffff0000, v8
    v_lshlrev_b32 v22, 16, v9
    v_and_b32 v23, 0xffff0000, v9
    v_lshlrev_b32 v24, 16, v10
    v_and_b32 v25, 0xffff0000, v10
    v_lshlrev_b32 v26, 16, v11
    v_and_b32 v27, 0xffff0000, v11
    s_waitcnt lgkmcnt(4)
    v_pk_add_f32 v[64:65], v[64:65], v[72:73]
    v_pk_add_f32 v[66:67], v[66:67], v[74:75]
    v_pk_add_f32 v[68:69], v[68:69], v[76:77]
    v_pk_add_f32 v[70:71], v[70:71], v[78:79]
    v_fmac_f32 v71, s62, v20
    v_fmac_f32 v67, s62, v21
    v_fmac_f32 v70, s62, v22
    v_fmac_f32 v66, s62, v23
    v_fmac_f32 v69, s62, v24
    v_fmac_f32 v65, s62, v25
    v_fmac_f32 v68, s62, v26
    v_fmac_f32 v64, s62, v27
    s_waitcnt lgkmcnt(0)
    v_pk_add_f32 v[80:81], v[80:81], v[88:89]
    v_pk_add_f32 v[82:83], v[82:83], v[90:91]
    v_pk_add_f32 v[84:85], v[84:85], v[92:93]
    v_pk_add_f32 v[86:87], v[86:87], v[94:95]
    v_pk_add_f32 v[64:65], v[64:65], v[80:81]
    v_pk_add_f32 v[66:67], v[66:67], v[82:83]
    v_pk_add_f32 v[68:69], v[68:69], v[84:85]
    v_pk_add_f32 v[70:71], v[70:71], v[86:87]
    v_cvt_pk_bf16_f32 v8, v64, v68
    v_cvt_pk_bf16_f32 v9, v65, v69
    v_cvt_pk_bf16_f32 v10, v66, v70
    v_cvt_pk_bf16_f32 v11, v67, v71
    s_lshl_b32 s64, s2, 13
    s_lshl_b32 s65, s61, 12
    s_add_u32 s64, s64, s65
    s_lshl_b32 s65, s60, 10
    s_add_u32 s64, s64, s65
    s_add_u32 s64, s64, 10485760
    buffer_store_dwordx4 v[8:11], v56, s[32:35], s64 offen sc1
    s_nop 1
    v_lshrrev_b32 v8, 3, v1
    v_and_b32 v11, 7, v1
    s_lshl_b32 s64, s54, 6
    s_lshl_b32 s65, s3, 3
    s_add_u32 s64, s64, s65
    v_add_u32 v9, s64, v8
    v_mul_u32_u24 v10, 896, v9
    v_lshl_add_u32 v3, v11, 4, v10
    v_lshlrev_b32 v5, 3, v9
    v_lshrrev_b32 v9, 3, v0
    v_lshlrev_b32 v9, 12, v9
    v_lshl_add_u32 v4, v11, 4, v9
    s_lshl_b32 s53, s51, 7
    s_lshl_b32 s64, s60, 13
    v_add_u32 v6, s64, v56
    v_add_u32 v7, 126976, v6
    v_add_u32 v50, 81920, v6
    v_add_u32 v51, s58, v56
    buffer_load_dwordx4 v[32:35], v3, s[4:7], s53 offen
    s_mov_b32 s64, 12582912
    buffer_load_dwordx2 v[36:37], v5, s[32:35], s64 offen sc1
    v_bfe_u32 v9, v1, 1, 2
    v_and_b32 v10, 1, v1
    v_lshl_add_u32 v9, v10, 2, v9
    v_lshlrev_b32 v10, 2, v15
    v_xor_b32 v10, v10, v9
    s_lshl_b32 s64, s3, 13
    s_add_u32 s64, s64, 49152
    v_lshl_add_u32 v9, v14, 7, s64
    v_xor_b32 v12, 0, v10
    v_lshl_add_u32 v44, v12, 4, v9
    v_xor_b32 v12, 1, v10
    v_lshl_add_u32 v45, v12, 4, v9
    v_xor_b32 v12, 2, v10
    v_lshl_add_u32 v46, v12, 4, v9
    v_xor_b32 v12, 3, v10
    v_lshl_add_u32 v47, v12, 4, v9
    v_xor_b32 v2, s3, v11
    v_lshlrev_b32 v2, 4, v2
    v_lshl_add_u32 v10, v8, 7, v2
    v_lshl_add_u32 v2, v11, 10, v2
    v_lshl_add_u32 v2, v8, 1, v2
    v_add_u32 v2, 118784, v2
    s_lshl_b32 s64, s3, 10
    s_add_u32 s65, s64, 118784
    v_add_u32 v10, s65, v10
    v_bfe_u32 v9, v1, 4, 2
    v_bfe_u32 v12, v1, 3, 1
    v_lshl_add_u32 v9, v12, 2, v9
    v_and_b32 v13, 3, v1
    v_lshlrev_b32 v13, 1, v13
    v_xor_b32 v13, v13, v9
    v_bfe_u32 v9, v1, 2, 1
    v_lshlrev_b32 v9, 13, v9
    v_lshl_add_u32 v9, v8, 7, v9
    s_add_u32 s64, s64, 49152
    v_add_u32 v9, s64, v9
    v_lshl_add_u32 v12, v13, 4, v9
    v_xor_b32 v13, 1, v13
    v_lshl_add_u32 v13, v13, 4, v9
    s_waitcnt vmcnt(7)
    s_barrier
    ds_read_b128 v[16:19], v51 offset:0
    ds_read_b128 v[20:23], v51 offset:4096
    ds_read_b128 v[24:27], v51 offset:1024
    ds_read_b128 v[28:31], v51 offset:5120
    s_waitcnt lgkmcnt(3)
    v_mfma_f32_32x32x16_bf16 v[64:79], v[128:131], v[16:19], 0
    s_add_u32 s69, s59, 8192
    s_add_u32 m0, s57, 49152
    s_nop 0
    buffer_load_dwordx4 v56, s[32:35], s69 offen offset:0 sc1 lds
    buffer_load_dwordx4 v56, s[32:35], s69 offen offset:1024 sc1 lds
    s_waitcnt lgkmcnt(2)
    v_mfma_f32_32x32x16_bf16 v[80:95], v[128:131], v[20:23], 0
    ds_read_b128 v[16:19], v51 offset:2048
    ds_read_b128 v[20:23], v51 offset:6144
    s_waitcnt lgkmcnt(3)
    v_mfma_f32_32x32x16_bf16 v[64:79], v[132:135], v[24:27], v[64:79]
    s_add_u32 s69, s59, 8192
    s_add_u32 m0, s57, 49152
    s_nop 0
    buffer_load_dwordx4 v56, s[32:35], s69 offen offset:2048 sc1 lds
    buffer_load_dwordx4 v56, s[32:35], s69 offen offset:3072 sc1 lds
    s_waitcnt lgkmcnt(2)
    v_mfma_f32_32x32x16_bf16 v[80:95], v[132:135], v[28:31], v[80:95]
    ds_read_b128 v[24:27], v51 offset:3072
    ds_read_b128 v[28:31], v51 offset:7168
    s_waitcnt lgkmcnt(3)
    v_mfma_f32_32x32x16_bf16 v[64:79], v[136:139], v[16:19], v[64:79]
    s_add_u32 s69, s59, 12288
    s_add_u32 m0, s57, 81920
    s_nop 0
    buffer_load_dwordx4 v56, s[32:35], s69 offen offset:0 sc1 lds
    buffer_load_dwordx4 v56, s[32:35], s69 offen offset:1024 sc1 lds
    s_waitcnt lgkmcnt(2)
    v_mfma_f32_32x32x16_bf16 v[80:95], v[136:139], v[20:23], v[80:95]
    s_waitcnt lgkmcnt(0)
    s_waitcnt vmcnt(8)
    s_barrier
    ds_read_b128 v[16:19], v7 offset:0
    ds_read_b128 v[20:23], v7 offset:4096
    v_mfma_f32_32x32x16_bf16 v[64:79], v[140:143], v[24:27], v[64:79]
    s_add_u32 s69, s59, 12288
    s_add_u32 m0, s57, 81920
    s_nop 0
    buffer_load_dwordx4 v56, s[32:35], s69 offen offset:2048 sc1 lds
    buffer_load_dwordx4 v56, s[32:35], s69 offen offset:3072 sc1 lds
    v_mfma_f32_32x32x16_bf16 v[80:95], v[140:143], v[28:31], v[80:95]
    s_cmp_lg_u32 s3, 0
    s_cbranch_scc1 L_nf_25
    v_mov_b32 v48, s71
    s_lshl_b32 s64, s2, 7
    s_add_u32 s64, s64, 13762560
    v_mov_b32 v49, s64
    s_mov_b64 exec, 1
    buffer_store_dword v48, v49, s[32:35], 0 offen sc1
    s_mov_b64 exec, -1
L_nf_25:
    ds_read_b128 v[24:27], v7 offset:1024
    ds_read_b128 v[28:31], v7 offset:5120
    s_waitcnt lgkmcnt(3)
    v_mfma_f32_32x32x16_bf16 v[64:79], v[144:147], v[16:19], v[64:79]
    s_waitcnt vmcnt(8)
    v_lshlrev_b32 v96, 16, v32
    v_and_b32 v97, 0xffff0000, v32
    v_lshlrev_b32 v98, 16, v33
    v_and_b32 v99, 0xffff0000, v33
    s_waitcnt lgkmcnt(2)
    v_mfma_f32_32x32x16_bf16 v[80:95], v[144:147], v[20:23], v[80:95]
    v_lshlrev_b32 v100, 16, v34
    v_and_b32 v101, 0xffff0000, v34
    v_lshlrev_b32 v102, 16, v35
    v_and_b32 v103, 0xffff0000, v35
    ds_read_b128 v[16:19], v7 offset:2048
    ds_read_b128 v[20:23], v7 offset:6144
    s_waitcnt lgkmcnt(3)
    v_mfma_f32_32x32x16_bf16 v[64:79], v[148:151], v[24:27], v[64:79]
    s_add_u32 s69, s59, 16384
    s_add_u32 m0, s57, 0
    s_nop 0
    buffer_load_dwordx4 v56, s[32:35], s69 offen offset:0 sc1 lds
    buffer_load_dwordx4 v56, s[32:35], s69 offen offset:1024 sc1 lds
    v_sub_f32 v104, v96, v36
    v_sub_f32 v105, v97, v36
    v_sub_f32 v106, v98, v36
    v_sub_f32 v107, v99, v36
    s_waitcnt lgkmcnt(2)
    v_mfma_f32_32x32x16_bf16 v[80:95], v[148:151], v[28:31], v[80:95]
    v_sub_f32 v108, v100, v36
    v_sub_f32 v109, v101, v36
    v_sub_f32 v110, v102, v36
    v_sub_f32 v111, v103, v36
    ds_read_b128 v[24:27], v7 offset:3072
    ds_read_b128 v[28:31], v7 offset:7168
    s_waitcnt lgkmcnt(3)
    v_mfma_f32_32x32x16_bf16 v[64:79], v[152:155], v[16:19], v[64:79]
    s_add_u32 s69, s59, 16384
    s_add_u32 m0, s57, 0
    s_nop 0
    buffer_load_dwordx4 v56, s[32:35], s69 offen offset:2048 sc1 lds
    buffer_load_dwordx4 v56, s[32:35], s69 offen offset:3072 sc1 lds
    v_cvt_pk_bf16_f32 v120, v104, v105
    v_cvt_pk_bf16_f32 v121, v106, v107
    v_cvt_pk_bf16_f32 v122, v108, v109
    v_cvt_pk_bf16_f32 v123, v110, v111
    s_waitcnt lgkmcnt(2)
    v_mfma_f32_32x32x16_bf16 v[80:95], v[152:155], v[20:23], v[80:95]
    v_lshlrev_b32 v104, 16, v120
    v_and_b32 v105, 0xffff0000, v120
    v_lshlrev_b32 v106, 16, v121
    v_and_b32 v107, 0xffff0000, v121
    s_waitcnt lgkmcnt(0)
    s_waitcnt vmcnt(8)
    s_barrier
    ds_read_b128 v[16:19], v6 offset:49152
    ds_read_b128 v[20:23], v6 offset:53248
    v_mfma_f32_32x32x16_bf16 v[64:79], v[156:159], v[24:27], v[64:79]
    v_lshlrev_b32 v108, 16, v122
    v_and_b32 v109, 0xffff0000, v122
    v_lshlrev_b32 v110, 16, v123
    v_and_b32 v111, 0xffff0000, v123
    v_mfma_f32_32x32x16_bf16 v[80:95], v[156:159], v[28:31], v[80:95]
    v_mul_f32 v104, v104, v37
    v_mul_f32 v105, v105, v37
    v_mul_f32 v106, v106, v37
    v_mul_f32 v107, v107, v37
    ds_read_b128 v[24:27], v6 offset:50176
    ds_read_b128 v[28:31], v6 offset:54272
    s_waitcnt lgkmcnt(3)
    v_mfma_f32_32x32x16_bf16 v[64:79], v[160:163], v[16:19], v[64:79]
    v_mul_f32 v108, v108, v37
    v_mul_f32 v109, v109, v37
    v_mul_f32 v110, v110, v37
    v_mul_f32 v111, v111, v37
    s_waitcnt lgkmcnt(2)
    v_mfma_f32_32x32x16_bf16 v[80:95], v[160:163], v[20:23], v[80:95]
    v_cvt_pk_bf16_f32 v120, v104, v105
    v_cvt_pk_bf16_f32 v121, v106, v107
    v_cvt_pk_bf16_f32 v122, v108, v109
    v_cvt_pk_bf16_f32 v123, v110, v111
    ds_read_b128 v[16:19], v6 offset:51200
    ds_read_b128 v[20:23], v6 offset:55296
    s_waitcnt lgkmcnt(3)
    v_mfma_f32_32x32x16_bf16 v[64:79], v[164:167], v[24:27], v[64:79]
    v_lshlrev_b32 v104, 16, v120
    v_and_b32 v105, 0xffff0000, v120
    v_lshlrev_b32 v106, 16, v121
    v_and_b32 v107, 0xffff0000, v121
    s_waitcnt lgkmcnt(2)
    v_mfma_f32_32x32x16_bf16 v[80:95], v[164:167], v[28:31], v[80:95]
    v_lshlrev_b32 v108, 16, v122
    v_and_b32 v109, 0xffff0000, v122
    v_lshlrev_b32 v110, 16, v123
    v_and_b32 v111, 0xffff0000, v123
    ds_read_b128 v[24:27], v6 offset:52224
    ds_read_b128 v[28:31], v6 offset:56320
    s_waitcnt lgkmcnt(3)
    v_mfma_f32_32x32x16_bf16 v[64:79], v[168:171], v[16:19], v[64:79]
    s_waitcnt lgkmcnt(2)
    v_mfma_f32_32x32x16_bf16 v[80:95], v[168:171], v[20:23], v[80:95]
    s_waitcnt lgkmcnt(0)
    s_waitcnt vmcnt(4)
    s_barrier
    ds_read_b128 v[16:19], v50 offset:0
    ds_read_b128 v[20:23], v50 offset:4096
    v_mfma_f32_32x32x16_bf16 v[64:79], v[172:175], v[24:27], v[64:79]
    s_add_u32 s69, s59, 20480
    s_add_u32 m0, s57, 49152
    s_nop 0
    buffer_load_dwordx4 v56, s[32:35], s69 offen offset:0 sc1 lds
    buffer_load_dwordx4 v56, s[32:35], s69 offen offset:1024 sc1 lds
    v_mfma_f32_32x32x16_bf16 v[80:95], v[172:175], v[28:31], v[80:95]
    ds_read_b128 v[24:27], v50 offset:1024
    ds_read_b128 v[28:31], v50 offset:5120
    s_waitcnt lgkmcnt(3)
    v_mfma_f32_32x32x16_bf16 v[64:79], v[176:179], v[16:19], v[64:79]
    s_add_u32 s69, s59, 20480
    s_add_u32 m0, s57, 49152
    s_nop 0
    buffer_load_dwordx4 v56, s[32:35], s69 offen offset:2048 sc1 lds
    buffer_load_dwordx4 v56, s[32:35], s69 offen offset:3072 sc1 lds
    s_lshl_b32 s64, s51, 5
    s_lshl_b32 s65, s3, 2
    s_add_u32 s64, s64, s65
    v_and_b32 v58, 3, v1
    v_add_u32 v58, s64, v58
    v_lshlrev_b32 v58, 7, v58
    v_add_u32 v58, 13762560, v58
    buffer_load_dword v57, v58, s[32:35], 0 offen sc1
    s_waitcnt lgkmcnt(2)
    v_mfma_f32_32x32x16_bf16 v[80:95], v[176:179], v[20:23], v[80:95]
    ds_read_b128 v[16:19], v50 offset:2048
    ds_read_b128 v[20:23], v50 offset:6144
    s_waitcnt lgkmcnt(3)
    v_mfma_f32_32x32x16_bf16 v[64:79], v[180:183], v[24:27], v[64:79]
    s_add_u32 s69, s59, 24576
    s_add_u32 m0, s57, 126976
    s_nop 0
    buffer_load_dwordx4 v56, s[32:35], s69 offen offset:0 sc1 lds
    buffer_load_dwordx4 v56, s[32:35], s69 offen offset:1024 sc1 lds
    s_waitcnt lgkmcnt(2)
    v_mfma_f32_32x32x16_bf16 v[80:95], v[180:183], v[28:31], v[80:95]
    ds_read_b128 v[24:27], v50 offset:3072
    ds_read_b128 v[28:31], v50 offset:7168
    s_waitcnt lgkmcnt(3)
    v_mfma_f32_32x32x16_bf16 v[64:79], v[184:187], v[16:19], v[64:79]
    s_add_u32 s69, s59, 24576
    s_add_u32 m0, s57, 126976
    s_nop 0
    buffer_load_dwordx4 v56, s[32:35], s69 offen offset:2048 sc1 lds
    buffer_load_dwordx4 v56, s[32:35], s69 offen offset:3072 sc1 lds
    s_waitcnt lgkmcnt(2)
    v_mfma_f32_32x32x16_bf16 v[80:95], v[184:187], v[20:23], v[80:95]
    s_waitcnt lgkmcnt(0)
    s_waitcnt vmcnt(9)
    s_barrier
    ds_read_b128 v[16:19], v6 offset:0
    ds_read_b128 v[20:23], v6 offset:4096
    v_mfma_f32_32x32x16_bf16 v[64:79], v[188:191], v[24:27], v[64:79]
    v_mfma_f32_32x32x16_bf16 v[80:95], v[188:191], v[28:31], v[80:95]
    ds_read_b128 v[24:27], v6 offset:1024
    ds_read_b128 v[28:31], v6 offset:5120
    s_waitcnt lgkmcnt(3)
    v_mfma_f32_32x32x16_bf16 v[64:79], v[192:195], v[16:19], v[64:79]
    s_waitcnt lgkmcnt(2)
    v_mfma_f32_32x32x16_bf16 v[80:95], v[192:195], v[20:23], v[80:95]
    ds_read_b128 v[16:19], v6 offset:2048
    ds_read_b128 v[20:23], v6 offset:6144
    s_waitcnt lgkmcnt(3)
    v_mfma_f32_32x32x16_bf16 v[64:79], v[196:199], v[24:27], v[64:79]
    s_mov_b32 s70, 0
    s_waitcnt vmcnt(4)
    s_branch L_chk_28
L_poll_27:
    buffer_load_dword v57, v58, s[32:35], 0 offen sc1
    s_waitcnt vmcnt(0)
L_chk_28:
    v_cmp_ne_u32 vcc, s71, v57
    s_nop 1
    s_cmp_eq_u64 vcc, 0
    s_cbranch_scc1 L_np_26
    s_add_u32 s70, s70, 1
    s_cmp_lt_u32 s70, 100000
    s_cbranch_scc1 L_poll_27
L_np_26:
    s_lshl_b32 s64, s51, 18
    s_lshl_b32 s65, s54, 7
    s_add_u32 s64, s64, s65
    s_add_u32 s64, s64, 10485760
    buffer_load_dwordx4 v[40:43], v4, s[32:35], s64 offen sc1
    s_waitcnt lgkmcnt(2)
    v_mfma_f32_32x32x16_bf16 v[80:95], v[196:199], v[28:31], v[80:95]
    ds_read_b128 v[24:27], v6 offset:3072
    ds_read_b128 v[28:31], v6 offset:7168
    s_waitcnt lgkmcnt(3)
    v_mfma_f32_32x32x16_bf16 v[64:79], v[200:203], v[16:19], v[64:79]
    s_waitcnt lgkmcnt(2)
    v_mfma_f32_32x32x16_bf16 v[80:95], v[200:203], v[20:23], v[80:95]
    s_waitcnt lgkmcnt(0)
    s_waitcnt vmcnt(6)
    s_barrier
    ds_read_b128 v[16:19], v6 offset:49152
    ds_read_b128 v[20:23], v6 offset:53248
    v_mfma_f32_32x32x16_bf16 v[64:79], v[204:207], v[24:27], v[64:79]
    v_mfma_f32_32x32x16_bf16 v[80:95], v[204:207], v[28:31], v[80:95]
    ds_read_b128 v[24:27], v6 offset:50176
    ds_read_b128 v[28:31], v6 offset:54272
    s_waitcnt lgkmcnt(3)
    v_mfma_f32_32x32x16_bf16 v[64:79], v[208:211], v[16:19], v[64:79]
    s_waitcnt lgkmcnt(2)
    v_mfma_f32_32x32x16_bf16 v[80:95], v[208:211], v[20:23], v[80:95]
    ds_read_b128 v[16:19], v6 offset:51200
    ds_read_b128 v[20:23], v6 offset:55296
    s_waitcnt lgkmcnt(3)
    v_mfma_f32_32x32x16_bf16 v[64:79], v[212:215], v[24:27], v[64:79]
    s_waitcnt lgkmcnt(2)
    v_mfma_f32_32x32x16_bf16 v[80:95], v[212:215], v[28:31], v[80:95]
    ds_read_b128 v[24:27], v6 offset:52224
    ds_read_b128 v[28:31], v6 offset:56320
    s_waitcnt lgkmcnt(3)
    v_mfma_f32_32x32x16_bf16 v[64:79], v[216:219], v[16:19], v[64:79]
    s_waitcnt vmcnt(0)
    ds_write_b16 v2, v40 offset:0
    ds_write_b16_d16_hi v2, v40 offset:128
    ds_write_b16 v2, v41 offset:256
    ds_write_b16_d16_hi v2, v41 offset:384
    ds_write_b16 v2, v42 offset:512
    ds_write_b16_d16_hi v2, v42 offset:640
    ds_write_b16 v2, v43 offset:768
    ds_write_b16_d16_hi v2, v43 offset:896
    s_waitcnt lgkmcnt(10)
    v_mfma_f32_32x32x16_bf16 v[80:95], v[216:219], v[20:23], v[80:95]
    s_waitcnt lgkmcnt(0)
    s_waitcnt vmcnt(1)
    s_barrier
    ds_read_b128 v[16:19], v7 offset:0
    ds_read_b128 v[20:23], v7 offset:4096
    v_mfma_f32_32x32x16_bf16 v[64:79], v[220:223], v[24:27], v[64:79]
    ds_read_b128 v[40:43], v10
    v_mfma_f32_32x32x16_bf16 v[80:95], v[220:223], v[28:31], v[80:95]
    ds_read_b128 v[24:27], v7 offset:1024
    ds_read_b128 v[28:31], v7 offset:5120
    s_waitcnt lgkmcnt(4)
    v_mfma_f32_32x32x16_bf16 v[64:79], v[224:227], v[16:19], v[64:79]
    s_waitcnt lgkmcnt(2)
    v_lshlrev_b32 v112, 16, v40
    v_and_b32 v113, 0xffff0000, v40
    v_lshlrev_b32 v114, 16, v41
    v_and_b32 v115, 0xffff0000, v41
    v_lshlrev_b32 v116, 16, v42
    v_and_b32 v117, 0xffff0000, v42
    s_waitcnt lgkmcnt(3)
    v_mfma_f32_32x32x16_bf16 v[80:95], v[224:227], v[20:23], v[80:95]
    v_lshlrev_b32 v118, 16, v43
    v_and_b32 v119, 0xffff0000, v43
    v_mul_f32 v104, v104, v112
    v_mul_f32 v105, v105, v113
    v_mul_f32 v106, v106, v114
    v_mul_f32 v107, v107, v115
    ds_read_b128 v[16:19], v7 offset:2048
    ds_read_b128 v[20:23], v7 offset:6144
    s_waitcnt lgkmcnt(3)
    v_mfma_f32_32x32x16_bf16 v[64:79], v[228:231], v[24:27], v[64:79]
    v_mul_f32 v108, v108, v116
    v_mul_f32 v109, v109, v117
    v_mul_f32 v110, v110, v118
    v_mul_f32 v111, v111, v119
    v_cvt_pk_bf16_f32 v120, v104, v105
    v_cvt_pk_bf16_f32 v121, v106, v107
    s_waitcnt lgkmcnt(2)
    v_mfma_f32_32x32x16_bf16 v[80:95], v[228:231], v[28:31], v[80:95]
    v_cvt_pk_bf16_f32 v122, v108, v109
    v_cvt_pk_bf16_f32 v123, v110, v111
    v_lshlrev_b32 v104, 16, v120
    v_and_b32 v105, 0xffff0000, v120
    v_lshlrev_b32 v106, 16, v121
    v_and_b32 v107, 0xffff0000, v121
    ds_read_b128 v[24:27], v7 offset:3072
    ds_read_b128 v[28:31], v7 offset:7168
    s_waitcnt lgkmcnt(3)
    v_mfma_f32_32x32x16_bf16 v[64:79], v[232:235], v[16:19], v[64:79]
    v_lshlrev_b32 v108, 16, v122
    v_and_b32 v109, 0xffff0000, v122
    v_lshlrev_b32 v110, 16, v123
    v_and_b32 v111, 0xffff0000, v123
    v_add_f32 v104, v104, v96
    v_add_f32 v105, v105, v97
    s_waitcnt lgkmcnt(2)
    v_mfma_f32_32x32x16_bf16 v[80:95], v[232:235], v[20:23], v[80:95]
    v_add_f32 v106, v106, v98
    v_add_f32 v107, v107, v99
    v_add_f32 v108, v108, v100
    v_add_f32 v109, v109, v101
    v_add_f32 v110, v110, v102
    v_add_f32 v111, v111, v103
    s_waitcnt lgkmcnt(1)
    v_mfma_f32_32x32x16_bf16 v[64:79], v[236:239], v[24:27], v[64:79]
    v_cvt_pk_bf16_f32 v120, v104, v105
    v_cvt_pk_bf16_f32 v121, v106, v107
    v_cvt_pk_bf16_f32 v122, v108, v109
    v_cvt_pk_bf16_f32 v123, v110, v111
    v_lshlrev_b32 v104, 16, v120
    v_and_b32 v105, 0xffff0000, v120
    s_waitcnt lgkmcnt(0)
    v_mfma_f32_32x32x16_bf16 v[80:95], v[236:239], v[28:31], v[80:95]
    v_lshlrev_b32 v106, 16, v121
    v_and_b32 v107, 0xffff0000, v121
    v_lshlrev_b32 v108, 16, v122
    v_and_b32 v109, 0xffff0000, v122
    v_lshlrev_b32 v110, 16, v123
    v_and_b32 v111, 0xffff0000, v123
    ds_write_b128 v44, v[64:67] offset:0
    ds_write_b128 v45, v[68:71] offset:0
    ds_write_b128 v46, v[72:75] offset:0
    ds_write_b128 v47, v[76:79] offset:0
    s_nop 1
    ds_write_b128 v44, v[80:83] offset:4096
    ds_write_b128 v45, v[84:87] offset:4096
    ds_write_b128 v46, v[88:91] offset:4096
    ds_write_b128 v47, v[92:95] offset:4096
    s_waitcnt lgkmcnt(0)
    s_barrier
    ds_read_b128 v[128:131], v12 offset:0
    ds_read_b128 v[132:135], v13 offset:0
    ds_read_b128 v[136:139], v12 offset:16384
    ds_read_b128 v[140:143], v13 offset:16384
    ds_read_b128 v[144:147], v12 offset:32768
    ds_read_b128 v[148:151], v13 offset:32768
    ds_read_b128 v[152:155], v12 offset:49152
    ds_read_b128 v[156:159], v13 offset:49152
    s_waitcnt lgkmcnt(4)
    v_pk_add_f32 v[128:129], v[128:129], v[136:137]
    v_pk_add_f32 v[130:131], v[130:131], v[138:139]
    v_pk_add_f32 v[132:133], v[132:133], v[140:141]
    v_pk_add_f32 v[134:135], v[134:135], v[142:143]
    s_waitcnt lgkmcnt(0)
    v_pk_add_f32 v[144:145], v[144:145], v[152:153]
    v_pk_add_f32 v[146:147], v[146:147], v[154:155]
    v_pk_add_f32 v[148:149], v[148:149], v[156:157]
    v_pk_add_f32 v[150:151], v[150:151], v[158:159]
    v_pk_add_f32 v[128:129], v[128:129], v[144:145]
    v_pk_add_f32 v[130:131], v[130:131], v[146:147]
    v_pk_add_f32 v[132:133], v[132:133], v[148:149]
    v_pk_add_f32 v[134:135], v[134:135], v[150:151]
    v_cvt_pk_bf16_f32 v120, v128, v129
    v_cvt_pk_bf16_f32 v121, v130, v131
    v_cvt_pk_bf16_f32 v122, v132, v133
    v_cvt_pk_bf16_f32 v123, v134, v135
    v_lshlrev_b32 v128, 16, v120
    v_and_b32 v129, 0xffff0000, v120
    v_lshlrev_b32 v130, 16, v121
    v_and_b32 v131, 0xffff0000, v121
    v_lshlrev_b32 v132, 16, v122
    v_and_b32 v133, 0xffff0000, v122
    v_lshlrev_b32 v134, 16, v123
    v_and_b32 v135, 0xffff0000, v123
    v_pk_add_f32 v[128:129], v[128:129], v[104:105]
    v_pk_add_f32 v[130:131], v[130:131], v[106:107]
    v_pk_add_f32 v[132:133], v[132:133], v[108:109]
    v_pk_add_f32 v[134:135], v[134:135], v[110:111]
    v_cvt_pk_bf16_f32 v120, v128, v129
    v_cvt_pk_bf16_f32 v121, v130, v131
    v_cvt_pk_bf16_f32 v122, v132, v133
    v_cvt_pk_bf16_f32 v123, v134, v135
    buffer_store_dwordx4 v[120:123], v3, s[28:31], s53 offen
    s_endpgm
L_free:
    s_and_b32 s64, s48, 3
    s_lshl_b32 s64, s64, 9
    s_lshr_b32 s65, s48, 2
    s_lshl_b32 s65, s65, 8
    s_add_u32 s64, s64, s65
    s_lshl_b32 s65, s51, 6
    s_add_u32 s64, s64, s65
    v_lshrrev_b32 v13, 3, v0
    v_add_u32 v13, s64, v13
    v_mul_u32_u24 v12, 896, v13
    v_and_b32 v14, 7, v0
    v_lshl_add_u32 v12, v14, 4, v12
    v_lshlrev_b32 v13, 3, v13
    v_lshl_add_u32 v13, v14, 28, v13
    s_sub_u32 s66, s2, 224
    v_lshrrev_b32 v2, 3, v1
    v_and_b32 v3, 7, v1
    v_bfe_u32 v4, v1, 4, 1
    v_lshlrev_b32 v4, 2, v4
    v_xor_b32 v3, v3, v4
    v_mul_u32_u24 v6, 896, v2
    v_lshl_add_u32 v6, v3, 4, v6
    s_mul_i32 s59, s66, 57344
    s_lshl_b32 s69, s3, 7
    s_add_u32 s59, s59, s69
    s_mul_i32 s60, s3, 224
    s_lshl_b32 s68, s66, 2
    s_add_u32 s60, s60, s68
    s_lshl_b32 s60, s60, 10
    s_add_u32 s60, s60, 16777216
    s_lshl_b32 s57, s3, 13
    s_cmp_lt_u32 s66, 28
    s_cselect_b32 s52, 7, 0
    s_waitcnt lgkmcnt(0)
    s_mov_b64 s[4:5], s[72:73]
    s_mov_b64 s[20:21], s[86:87]
    s_mov_b64 s[46:47], s[88:89]
    s_mov_b64 s[8:9], s[74:75]
    s_mov_b64 s[12:13], s[76:77]
    s_mov_b64 s[40:41], s[78:79]
    s_mov_b64 s[16:17], s[80:81]
    s_mov_b64 s[44:45], s[82:83]
    s_mov_b64 s[24:25], s[90:91]
    s_mov_b64 s[28:29], s[92:93]
    s_mov_b32 s70, 13631488
    s_load_dword s71, s[32:33], s70
    buffer_load_dwordx4 v[64:67], v12, s[4:7], 0 offen offset:0
    buffer_load_dwordx4 v[68:71], v12, s[4:7], 0 offen offset:128
    buffer_load_dwordx4 v[72:75], v12, s[4:7], 0 offen offset:256
    buffer_load_dwordx4 v[76:79], v12, s[4:7], 0 offen offset:384
    buffer_load_dwordx4 v[80:83], v12, s[4:7], 0 offen offset:512
    buffer_load_dwordx4 v[84:87], v12, s[4:7], 0 offen offset:640
    buffer_load_dwordx4 v[88:91], v12, s[4:7], 0 offen offset:768
    s_barrier
    s_cmp_ge_u32 s3, s52
    s_cbranch_scc1 L_fw_29
    s_add_u32 s64, s59, 0
    s_add_u32 m0, s57, 0
    s_nop 0
    buffer_load_dwordx4 v6, s[24:27], s64 offen lds
    s_add_u32 s64, s59, 7168
    s_add_u32 m0, s57, 1024
    s_nop 0
    buffer_load_dwordx4 v6, s[24:27], s64 offen lds
    s_add_u32 s64, s59, 14336
    s_add_u32 m0, s57, 2048
    s_nop 0
    buffer_load_dwordx4 v6, s[24:27], s64 offen lds
    s_add_u32 s64, s59, 21504
    s_add_u32 m0, s57, 3072
    s_nop 0
    buffer_load_dwordx4 v6, s[24:27], s64 offen lds
    s_add_u32 s64, s59, 28672
    s_add_u32 m0, s57, 4096
    s_nop 0
    buffer_load_dwordx4 v6, s[24:27], s64 offen lds
    s_add_u32 s64, s59, 35840
    s_add_u32 m0, s57, 5120
    s_nop 0
    buffer_load_dwordx4 v6, s[24:27], s64 offen lds
    s_add_u32 s64, s59, 43008
    s_add_u32 m0, s57, 6144
    s_nop 0
    buffer_load_dwordx4 v6, s[24:27], s64 offen lds
    s_add_u32 s64, s59, 50176
    s_add_u32 m0, s57, 7168
    s_nop 0
    buffer_load_dwordx4 v6, s[24:27], s64 offen lds
    s_waitcnt vmcnt(8)
    s_branch L_fw_30
L_fw_29:
    s_waitcnt vmcnt(0)
L_fw_30:
    v_lshlrev_b32 v160, 16, v64
    v_and_b32 v161, 0xffff0000, v64
    v_lshlrev_b32 v162, 16, v65
    v_and_b32 v163, 0xffff0000, v65
    v_lshlrev_b32 v164, 16, v66
    v_and_b32 v165, 0xffff0000, v66
    v_lshlrev_b32 v166, 16, v67
    v_and_b32 v167, 0xffff0000, v67
    v_lshlrev_b32 v168, 16, v68
    v_and_b32 v169, 0xffff0000, v68
    v_lshlrev_b32 v170, 16, v69
    v_and_b32 v171, 0xffff0000, v69
    v_lshlrev_b32 v172, 16, v70
    v_and_b32 v173, 0xffff0000, v70
    v_lshlrev_b32 v174, 16, v71
    v_and_b32 v175, 0xffff0000, v71
    v_lshlrev_b32 v176, 16, v72
    v_and_b32 v177, 0xffff0000, v72
    v_lshlrev_b32 v178, 16, v73
    v_and_b32 v179, 0xffff0000, v73
    v_lshlrev_b32 v180, 16, v74
    v_and_b32 v181, 0xffff0000, v74
    v_lshlrev_b32 v182, 16, v75
    v_and_b32 v183, 0xffff0000, v75
    v_lshlrev_b32 v184, 16, v76
    v_and_b32 v185, 0xffff0000, v76
    v_lshlrev_b32 v186, 16, v77
    v_and_b32 v187, 0xffff0000, v77
    v_lshlrev_b32 v188, 16, v78
    v_and_b32 v189, 0xffff0000, v78
    v_lshlrev_b32 v190, 16, v79
    v_and_b32 v191, 0xffff0000, v79
    v_lshlrev_b32 v192, 16, v80
    v_and_b32 v193, 0xffff0000, v80
    v_lshlrev_b32 v194, 16, v81
    v_and_b32 v195, 0xffff0000, v81
    v_lshlrev_b32 v196, 16, v82
    v_and_b32 v197, 0xffff0000, v82
    v_lshlrev_b32 v198, 16, v83
    v_and_b32 v199, 0xffff0000, v83
    v_lshlrev_b32 v200, 16, v84
    v_and_b32 v201, 0xffff0000, v84
    v_lshlrev_b32 v202, 16, v85
    v_and_b32 v203, 0xffff0000, v85
    v_lshlrev_b32 v204, 16, v86
    v_and_b32 v205, 0xffff0000, v86
    v_lshlrev_b32 v206, 16, v87
    v_and_b32 v207, 0xffff0000, v87
    v_lshlrev_b32 v208, 16, v88
    v_and_b32 v209, 0xffff0000, v88
    v_lshlrev_b32 v210, 16, v89
    v_and_b32 v211, 0xffff0000, v89
    v_lshlrev_b32 v212, 16, v90
    v_and_b32 v213, 0xffff0000, v90
    v_lshlrev_b32 v214, 16, v91
    v_and_b32 v215, 0xffff0000, v91
    v_pk_add_f32 v[16:17], v[160:161], v[162:163]
    v_pk_add_f32 v[18:19], v[164:165], v[166:167]
    v_pk_add_f32 v[16:17], v[16:17], v[168:169]
    v_pk_add_f32 v[18:19], v[18:19], v[170:171]
    v_pk_add_f32 v[16:17], v[16:17], v[172:173]
    v_pk_add_f32 v[18:19], v[18:19], v[174:175]
    v_pk_add_f32 v[16:17], v[16:17], v[176:177]
    v_pk_add_f32 v[18:19], v[18:19], v[178:179]
    v_pk_add_f32 v[16:17], v[16:17], v[180:181]
    v_pk_add_f32 v[18:19], v[18:19], v[182:183]
    v_pk_add_f32 v[16:17], v[16:17], v[184:185]
    v_pk_add_f32 v[18:19], v[18:19], v[186:187]
    v_pk_add_f32 v[16:17], v[16:17], v[188:189]
    v_pk_add_f32 v[18:19], v[18:19], v[190:191]
    v_pk_add_f32 v[16:17], v[16:17], v[192:193]
    v_pk_add_f32 v[18:19], v[18:19], v[194:195]
    v_pk_add_f32 v[16:17], v[16:17], v[196:197]
    v_pk_add_f32 v[18:19], v[18:19], v[198:199]
    v_pk_add_f32 v[16:17], v[16:17], v[200:201]
    v_pk_add_f32 v[18:19], v[18:19], v[202:203]
    v_pk_add_f32 v[16:17], v[16:17], v[204:205]
    v_pk_add_f32 v[18:19], v[18:19], v[206:207]
    v_pk_add_f32 v[16:17], v[16:17], v[208:209]
    v_pk_add_f32 v[18:19], v[18:19], v[210:211]
    v_pk_add_f32 v[16:17], v[16:17], v[212:213]
    v_pk_add_f32 v[18:19], v[18:19], v[214:215]
    v_pk_add_f32 v[16:17], v[16:17], v[18:19]
    v_add_f32 v16, v16, v17
    s_nop 1
    v_add_f32_dpp v16, v16, v16 quad_perm:[1,0,3,2] row_mask:0xf bank_mask:0xf
    s_nop 1
    v_add_f32_dpp v16, v16, v16 quad_perm:[2,3,0,1] row_mask:0xf bank_mask:0xf
    s_nop 1
    v_add_f32_dpp v16, v16, v16 row_half_mirror row_mask:0xf bank_mask:0xf
    v_mul_f32 v16, 0xbb124925, v16
    v_mov_b32 v17, v16
    v_pk_add_f32 v[160:161], v[160:161], v[16:17]
    v_pk_add_f32 v[162:163], v[162:163], v[16:17]
    v_pk_add_f32 v[164:165], v[164:165], v[16:17]
    v_pk_add_f32 v[166:167], v[166:167], v[16:17]
    v_pk_add_f32 v[168:169], v[168:169], v[16:17]
    v_pk_add_f32 v[170:171], v[170:171], v[16:17]
    v_pk_add_f32 v[172:173], v[172:173], v[16:17]
    v_pk_add_f32 v[174:175], v[174:175], v[16:17]
    v_pk_add_f32 v[176:177], v[176:177], v[16:17]
    v_pk_add_f32 v[178:179], v[178:179], v[16:17]
    v_pk_add_f32 v[180:181], v[180:181], v[16:17]
    v_pk_add_f32 v[182:183], v[182:183], v[16:17]
    v_pk_add_f32 v[184:185], v[184:185], v[16:17]
    v_pk_add_f32 v[186:187], v[186:187], v[16:17]
    v_pk_add_f32 v[188:189], v[188:189], v[16:17]
    v_pk_add_f32 v[190:191], v[190:191], v[16:17]
    v_pk_add_f32 v[192:193], v[192:193], v[16:17]
    v_pk_add_f32 v[194:195], v[194:195], v[16:17]
    v_pk_add_f32 v[196:197], v[196:197], v[16:17]
    v_pk_add_f32 v[198:199], v[198:199], v[16:17]
    v_pk_add_f32 v[200:201], v[200:201], v[16:17]
    v_pk_add_f32 v[202:203], v[202:203], v[16:17]
    v_pk_add_f32 v[204:205], v[204:205], v[16:17]
    v_pk_add_f32 v[206:207], v[206:207], v[16:17]
    v_pk_add_f32 v[208:209], v[208:209], v[16:17]
    v_pk_add_f32 v[210:211], v[210:211], v[16:17]
    v_pk_add_f32 v[212:213], v[212:213], v[16:17]
    v_pk_add_f32 v[214:215], v[214:215], v[16:17]
    v_pk_mul_f32 v[18:19], v[160:161], v[160:161]
    v_pk_mul_f32 v[20:21], v[162:163], v[162:163]
    v_pk_fma_f32 v[18:19], v[164:165], v[164:165], v[18:19]
    v_pk_fma_f32 v[20:21], v[166:167], v[166:167], v[20:21]
    v_pk_fma_f32 v[18:19], v[168:169], v[168:169], v[18:19]
    v_pk_fma_f32 v[20:21], v[170:171], v[170:171], v[20:21]
    v_pk_fma_f32 v[18:19], v[172:173], v[172:173], v[18:19]
    v_pk_fma_f32 v[20:21], v[174:175], v[174:175], v[20:21]
    v_pk_fma_f32 v[18:19], v[176:177], v[176:177], v[18:19]
    v_pk_fma_f32 v[20:21], v[178:179], v[178:179], v[20:21]
    v_pk_fma_f32 v[18:19], v[180:181], v[180:181], v[18:19]
    v_pk_fma_f32 v[20:21], v[182:183], v[182:183], v[20:21]
    v_pk_fma_f32 v[18:19], v[184:185], v[184:185], v[18:19]
    v_pk_fma_f32 v[20:21], v[186:187], v[186:187], v[20:21]
    v_pk_fma_f32 v[18:19], v[188:189], v[188:189], v[18:19]
    v_pk_fma_f32 v[20:21], v[190:191], v[190:191], v[20:21]
    v_pk_fma_f32 v[18:19], v[192:193], v[192:193], v[18:19]
    v_pk_fma_f32 v[20:21], v[194:195], v[194:195], v[20:21]
    v_pk_fma_f32 v[18:19], v[196:197], v[196:197], v[18:19]
    v_pk_fma_f32 v[20:21], v[198:199], v[198:199], v[20:21]
    v_pk_fma_f32 v[18:19], v[200:201], v[200:201], v[18:19]
    v_pk_fma_f32 v[20:21], v[202:203], v[202:203], v[20:21]
    v_pk_fma_f32 v[18:19], v[204:205], v[204:205], v[18:19]
    v_pk_fma_f32 v[20:21], v[206:207], v[206:207], v[20:21]
    v_pk_fma_f32 v[18:19], v[208:209], v[208:209], v[18:19]
    v_pk_fma_f32 v[20:21], v[210:211], v[210:211], v[20:21]
    v_pk_fma_f32 v[18:19], v[212:213], v[212:213], v[18:19]
    v_pk_fma_f32 v[20:21], v[214:215], v[214:215], v[20:21]
    v_pk_add_f32 v[18:19], v[18:19], v[20:21]
    v_add_f32 v18, v18, v19
    s_nop 1
    v_add_f32_dpp v18, v18, v18 quad_perm:[1,0,3,2] row_mask:0xf bank_mask:0xf
    s_nop 1
    v_add_f32_dpp v18, v18, v18 quad_perm:[2,3,0,1] row_mask:0xf bank_mask:0xf
    s_nop 1
    v_add_f32_dpp v18, v18, v18 row_half_mirror row_mask:0xf bank_mask:0xf
    v_mul_f32 v18, 0x3b124925, v18
    v_cvt_pk_bf16_f32 v18, v18, v18
    v_and_b32 v18, 0xffff0000, v18
    v_add_f32 v18, 0x3727c5ac, v18
    v_cvt_pk_bf16_f32 v18, v18, v18
    v_and_b32 v18, 0xffff0000, v18
    v_sqrt_f32 v18, v18
    s_nop 0
    v_cvt_pk_bf16_f32 v18, v18, v18
    v_and_b32 v18, 0xffff0000, v18
    v_rcp_f32 v23, v18
    v_xor_b32 v16, 0x80000000, v16
    v_cvt_pk_bf16_f32 v22, v16, v16
    v_and_b32 v22, 0xffff0000, v22
    v_lshrrev_b32 v8, 5, v1
    v_lshlrev_b32 v8, 10, v8
    v_bfe_u32 v9, v1, 2, 2
    v_lshl_add_u32 v8, v9, 7, v8
    v_and_b32 v9, 1, v1
    v_lshl_add_u32 v8, v9, 5, v8
    v_bfe_u32 v9, v1, 4, 1
    v_lshl_add_u32 v8, v9, 4, v8
    v_bfe_u32 v9, v1, 1, 1
    v_lshl_add_u32 v8, v9, 3, v8
    v_add_u32 v8, s57, v8
    v_bfe_u32 v9, v1, 3, 1
    v_xor_b32 v10, 1, v9
    v_lshl_add_u32 v11, v10, 6, v8
    v_lshl_add_u32 v10, v9, 6, v8
    v_lshlrev_b32 v9, 4, v1
    s_waitcnt vmcnt(0)
    s_cmp_ge_u32 s3, s52
    s_cbranch_scc1 L_fw_31
    ds_read_b64_tr_b16 v[128:129], v10 offset:0
    ds_read_b64_tr_b16 v[130:131], v10 offset:512
    ds_read_b64_tr_b16 v[132:133], v10 offset:2048
    ds_read_b64_tr_b16 v[134:135], v10 offset:2560
    ds_read_b64_tr_b16 v[136:137], v10 offset:4096
    ds_read_b64_tr_b16 v[138:139], v10 offset:4608
    ds_read_b64_tr_b16 v[140:141], v10 offset:6144
    ds_read_b64_tr_b16 v[142:143], v10 offset:6656
    ds_read_b64_tr_b16 v[144:145], v11 offset:0
    ds_read_b64_tr_b16 v[146:147], v11 offset:512
    ds_read_b64_tr_b16 v[148:149], v11 offset:2048
    ds_read_b64_tr_b16 v[150:151], v11 offset:2560
    ds_read_b64_tr_b16 v[152:153], v11 offset:4096
    ds_read_b64_tr_b16 v[154:155], v11 offset:4608
    ds_read_b64_tr_b16 v[156:157], v11 offset:6144
    ds_read_b64_tr_b16 v[158:159], v11 offset:6656
    s_waitcnt lgkmcnt(0)
    s_add_u32 s64, s60, 114688
    buffer_store_dwordx4 v[128:131], v9, s[32:35], s60 offen offset:0 sc1
    buffer_store_dwordx4 v[132:135], v9, s[32:35], s60 offen offset:1024 sc1
    buffer_store_dwordx4 v[136:139], v9, s[32:35], s60 offen offset:2048 sc1
    buffer_store_dwordx4 v[140:143], v9, s[32:35], s60 offen offset:3072 sc1
    buffer_store_dwordx4 v[144:147], v9, s[32:35], s64 offen offset:0 sc1
    buffer_store_dwordx4 v[148:151], v9, s[32:35], s64 offen offset:1024 sc1
    buffer_store_dwordx4 v[152:155], v9, s[32:35], s64 offen offset:2048 sc1
    buffer_store_dwordx4 v[156:159], v9, s[32:35], s64 offen offset:3072 sc1
L_fw_31:
    s_mov_b32 s68, 12582912
    buffer_store_dwordx2 v[22:23], v13, s[32:35], s68 offen sc1
    s_waitcnt vmcnt(0) lgkmcnt(0)
    s_add_u32 s71, s71, 0x9e3779b9
    s_barrier
    s_cmp_lg_u32 s3, 0
    s_cbranch_scc1 L_nf_32
    v_mov_b32 v2, s71
    s_lshl_b32 s64, s2, 7
    s_add_u32 s64, s64, 13664256
    v_mov_b32 v3, s64
    s_mov_b64 exec, 1
    buffer_store_dword v2, v3, s[32:35], 0 offen sc1
    s_mov_b64 exec, -1
L_nf_32:
    s_cmp_lg_u32 s3, 0
    s_cbranch_scc1 L_nf_33
    s_add_u32 s64, s2, 224
    s_lshl_b32 s64, s64, 7
    s_add_u32 s64, s64, 13893632
    v_mov_b32 v2, s71
    v_mov_b32 v3, s64
    s_mov_b64 exec, 1
    buffer_store_dword v2, v3, s[32:35], 0 offen sc1
    s_mov_b64 exec, -1
L_nf_33:
    s_sub_u32 s64, s2, 224
    v_lshlrev_b32 v6, 7, v0
    s_mul_i32 s65, s64, 57344
    v_cmp_gt_u32 vcc, 448, v0
    v_mov_b32 v7, 0x7fffff00
    s_nop 0
    v_cndmask_b32 v7, v7, v6, vcc
    buffer_load_dword v251, v7, s[16:19], s65 offen
    s_cmp_lg_u32 s2, 255
    s_cbranch_scc1 L_exit
    v_and_b32 v3, 255, v0
    v_cmp_gt_u32 vcc, 224, v3
    s_nop 1
    v_cndmask_b32 v4, 0, 1, vcc
    v_mul_u32_u24 v4, 256, v4
    v_add_u32 v3, v3, v4
    v_lshlrev_b32 v3, 7, v3
    v_add_u32 v3, 13664256, v3
    buffer_load_dword v2, v3, s[32:35], 0 offen sc1
    s_mov_b32 s70, 0
    s_waitcnt vmcnt(0)
    s_branch L_chk_36
L_poll_35:
    s_sleep 40
    buffer_load_dword v2, v3, s[32:35], 0 offen sc1
    s_waitcnt vmcnt(0)
L_chk_36:
    v_cmp_ne_u32 vcc, s71, v2
    s_nop 1
    s_cmp_eq_u64 vcc, 0
    s_cbranch_scc1 L_np_34
    s_add_u32 s70, s70, 1
    s_cmp_lt_u32 s70, 100000
    s_cbranch_scc1 L_poll_35
L_np_34:
    s_barrier
    s_cmp_lg_u32 s3, 0
    s_cbranch_scc1 L_exit
    v_mov_b32 v2, 13631488
    v_mov_b32 v3, s71
    s_mov_b64 exec, 1
    buffer_store_dword v3, v2, s[32:35], 0 offen sc1
L_exit:
    s_endpgm
L_codeend:

.section .rodata,"a"
.p2align 6
.amdhsa_kernel parallel_sum__ssm_conv_h3__glu_gated_swiglu__prompt_kernel
  .amdhsa_next_free_vgpr 256
  .amdhsa_next_free_sgpr 102
  .amdhsa_accum_offset 256
  .amdhsa_group_segment_fixed_size 0
  .amdhsa_kernarg_size 104
  .amdhsa_user_sgpr_count 2
  .amdhsa_user_sgpr_kernarg_segment_ptr 1
  .amdhsa_system_sgpr_workgroup_id_x 1
.end_amdhsa_kernel
```
